```python
import torch

def _softmax(x, axis=-1):
    return torch.softmax(x, dim=axis)
def _gelu(x):
    return torch.nn.functional.gelu(x, approximate="tanh")
def _silu(x):
    return torch.nn.functional.silu(x)
def _sigmoid(x):
    return torch.sigmoid(x)
def _layernorm(x, axis=-1, eps=1e-5):
    m = x.mean(dim=axis, keepdim=True)
    v = x.var(dim=axis, keepdim=True, unbiased=False)
    return (x - m) / torch.sqrt(v + eps)
def _scatter_add(tgt, idx, src, axis=0):
    return tgt.clone().index_add_(axis, idx, src)
def _segment_sum(src, seg, n):
    out = torch.zeros((n,) + src.shape[1:], dtype=src.dtype)
    return out.index_add_(0, seg, src)
def _pad(x, pw):
    flat = tuple(v for pair in reversed(pw) for v in pair)
    return torch.nn.functional.pad(x, flat)

kernel_name = 'standalone__adm_resblock__diffusion'

def setup_inputs():

    _w = (lambda a: (lambda t: t.to(torch.bfloat16) if t.is_floating_point() else t)(torch.as_tensor(a)))
    B, C, HW, E = 2, 128, 128, 768
    sc = (9.0 * C) ** -0.5
    return {
        "x": _w((lambda *s: torch.randn(*s, dtype=torch.bfloat16) * 0.05)(B, C, HW, HW)),
        "t_emb": _w((lambda *s: torch.randn(*s, dtype=torch.bfloat16) * 0.4)(B, E)),
        "g1": _w(1.0 + 0.1 * (lambda *s: torch.randn(*s, dtype=torch.bfloat16) * 0.4)(C)),
        "be1": _w(0.1 * (lambda *s: torch.randn(*s, dtype=torch.bfloat16) * 0.4)(C)),
        "w1": _w((lambda *s: torch.randn(*s, dtype=torch.bfloat16) * 0.4)(C, C, 3, 3) * sc),
        "w_emb": _w((lambda *s: torch.randn(*s, dtype=torch.bfloat16) * 0.4)(E, C) * (E ** -0.5)),
        "g2": _w(1.0 + 0.1 * (lambda *s: torch.randn(*s, dtype=torch.bfloat16) * 0.4)(C)),
        "be2": _w(0.1 * (lambda *s: torch.randn(*s, dtype=torch.bfloat16) * 0.4)(C)),
        "w2": _w((lambda *s: torch.randn(*s, dtype=torch.bfloat16) * 0.4)(C, C, 3, 3) * sc),
    }

def reference(x, t_emb, g1, be1, w1, w_emb, g2, be2, w2):
    B, C, H, W = x.shape
    G, eps = 4, 1e-5
    def gn(z, gamma, beta):
        zr = z.reshape(B, G, (C // G) * H * W)
        mu = zr.mean(-1).reshape(B, G, 1)
        var = ((zr - mu) ** 2).mean(-1).reshape(B, G, 1)
        zn = ((zr - mu) / torch.sqrt(var + eps)).reshape(B, C, H, W)
        return zn * gamma.reshape(1, C, 1, 1) + beta.reshape(1, C, 1, 1)
    def conv3(z, w):
        zp = _pad(z, ((0, 0), (0, 0), (1, 1), (1, 1)))
        taps = [torch.einsum("bchw,oc->bohw", zp[:, :, i:i+H, j:j+W], w[:, :, i, j]) for i in range(3) for j in range(3)]
        out = taps[0]
        for t in taps[1:]:
            out = out + t
        return out
    h = conv3(_silu(gn(x, g1, be1)), w1)
    emb = _silu(t_emb) @ w_emb
    h = h + emb.reshape(B, C, 1, 1)
    h = conv3(_silu(gn(h, g2, be2)), w2)
    return x + h
```

```asm
; @launch grid=(256,1,1) block=(512,1,1) lds=159488
.amdgcn_target "amdgcn-amd-amdhsa--gfx950"
.text
.globl standalone__adm_resblock__diffusion_kernel
.p2align 8
.type standalone__adm_resblock__diffusion_kernel,@function
standalone__adm_resblock__diffusion_kernel:
  s_load_dwordx16 s[4:19], s[0:1], 0
  s_load_dwordx8 s[20:27], s[0:1], 64
  s_cmp_ge_u32 s2, 256
  s_cbranch_scc1 L_end
  v_lshrrev_b32 v9, 6, v0
  v_and_b32 v1, 63, v0
  s_and_b32 s3, s2, 7
  v_readfirstlane_b32 s40, v9
  s_lshr_b32 s47, s2, 3
  s_lshr_b32 s41, s3, 2
  s_and_b32 s3, s3, 3
  s_lshl_b32 s44, s3, 5
  s_add_u32 s44, s44, s47
  s_cmp_ge_u32 s40, 1
  s_cbranch_scc1 L_e_h
  s_and_b32 s76, s44, 0x78
  s_and_b32 s78, s44, 7
  v_lshrrev_b32 v9, 3, v1
  v_and_b32 v11, 7, v1
  v_add_u32 v2, s76, v9
  v_mul_u32_u24 v2, 2304, v2
  v_mul_u32_u24 v3, 36, v11
  s_mul_i32 s75, s78, 288
  v_add3_u32 v15, v2, v3, s75
  s_cmp_eq_u32 s40, 0
  s_waitcnt lgkmcnt(0)
  s_cselect_b32 s80, s12, s20
  s_cselect_b32 s81, s13, s21
  global_load_dwordx3 v[160:162], v15, s[80:81] offset:0
  global_load_dwordx3 v[164:166], v15, s[80:81] offset:12
  global_load_dwordx3 v[168:170], v15, s[80:81] offset:24
  s_branch L_common
L_e_h:
  s_cmp_lt_u32 s40, 4
  s_cbranch_scc1 L_e_23
  v_subrev_u32 v11, 256, v0
  v_lshrrev_b32 v14, 6, v11
  v_bfe_u32 v11, v0, 2, 4
  v_lshl_add_u32 v11, v14, 5, v11
  v_and_b32 v14, 3, v0
  v_lshlrev_b32 v15, 4, v14
  v_lshl_add_u32 v12, v11, 15, v15
  v_add_u32 v87, 524288, v12
  s_lshl_b32 s70, s41, 22
  s_and_b32 s71, s44, 3
  s_lshl_b32 s71, s71, 6
  s_add_u32 s70, s70, s71
  s_and_b32 s71, s44, 0x7c
  s_lshl_b32 s71, s71, 8
  s_add_u32 s70, s70, s71
  s_and_b32 s71, s44, 1
  s_lshl_b32 s71, s71, 9
  s_add_u32 s70, s70, s71
  s_xor_b32 s71, s70, 512
  s_mov_b32 s30, 0x800000
  s_mov_b32 s31, 0x20000
  s_waitcnt lgkmcnt(0)
  s_mov_b64 s[28:29], s[4:5]
  buffer_load_dwordx4 v[16:19], v12, s[28:31], s70 offen offset:0 nt
  buffer_load_dwordx4 v[24:27], v12, s[28:31], s70 offen offset:256 nt
  buffer_load_dwordx4 v[20:23], v87, s[28:31], s70 offen offset:0 nt
  buffer_load_dwordx4 v[28:31], v87, s[28:31], s70 offen offset:256 nt
  buffer_load_dwordx4 v[32:35], v12, s[28:31], s71 offen offset:0 nt
  buffer_load_dwordx4 v[40:43], v12, s[28:31], s71 offen offset:256 nt
  buffer_load_dwordx4 v[36:39], v87, s[28:31], s71 offen offset:0 nt
  buffer_load_dwordx4 v[44:47], v87, s[28:31], s71 offen offset:256 nt
  s_branch L_common
L_e_23:
  s_waitcnt lgkmcnt(0)
L_common:
  s_lshl_b32 s74, s41, 7
  s_load_dword s46, s[26:27], s74
  s_lshr_b32 s42, s44, 2
  s_and_b32 s43, s44, 3
  s_add_u32 s45, s74, s44
  s_lshl_b32 s3, s45, 15
  s_add_u32 s3, s3, 0x400000
  s_mov_b32 s54, 0xbfb8aa3b
  s_mov_b32 s55, 0x3f803f80
  s_mov_b32 s56, 0xffff0000
  v_bfe_u32 v10, v0, 2, 6
  v_lshlrev_b32 v10, 7, v10
  v_and_b32 v4, 3, v0
  v_lshl_add_u32 v10, v4, 4, v10
  v_lshlrev_b32 v4, 4, v1
  s_mov_b64 s[28:29], s[4:5]
  s_mov_b32 s30, 0x800000
  s_mov_b32 s31, 0x20000
  s_mov_b64 s[32:33], s[26:27]
  s_mov_b32 s34, 0x10000000
  s_mov_b32 s35, 0x20000
  s_mov_b64 s[36:37], s[22:23]
  s_mov_b32 s38, 0x800000
  s_mov_b32 s39, 0x20000
  s_mov_b32 s25, 0
  s_lshl_b32 s70, s41, 22
  s_lshl_b32 s71, s43, 6
  s_add_u32 s70, s70, s71
  s_lshl_b32 s71, s42, 10
  s_add_u32 s49, s70, s71
  s_add_u32 s50, s49, 256
  s_add_u32 s51, s49, 512
  s_add_u32 s52, s49, 768
  s_sub_u32 s48, s49, 256
  s_add_u32 s53, s49, 1024
  s_cmp_eq_u32 s42, 0
  s_cselect_b32 s48, s49, s48
  s_cselect_b32 s57, 0x7f800000, 1.0
  s_cmp_eq_u32 s42, 31
  s_cselect_b32 s53, s52, s53
  s_cselect_b32 s58, 0x7f800000, 1.0
  s_cmp_ge_u32 s40, 4
  s_cbranch_scc1 L_helper
  s_cmp_ge_u32 s40, 2
  s_cbranch_scc1 L_m23
  s_cmp_eq_u32 s40, 0
  s_cbranch_scc1 L_w1
  s_barrier
  s_and_b32 s76, s44, 0x78
  s_and_b32 s78, s44, 7
  v_lshrrev_b32 v9, 3, v1
  v_and_b32 v11, 7, v1
  v_add_u32 v2, s76, v9
  v_mul_u32_u24 v2, 2304, v2
  v_mul_u32_u24 v3, 36, v11
  s_mul_i32 s75, s78, 288
  v_add3_u32 v15, v2, v3, s75
  s_cmp_eq_u32 s40, 0
  s_cselect_b32 s80, s12, s20
  s_cselect_b32 s81, s13, s21
  global_load_dwordx3 v[160:162], v15, s[80:81] offset:0
  global_load_dwordx3 v[164:166], v15, s[80:81] offset:12
  global_load_dwordx3 v[168:170], v15, s[80:81] offset:24
  s_branch L_mjoin
L_w1:
  s_lshr_b32 s77, s44, 3
  s_and_b32 s78, s44, 7
  s_mul_i32 s79, s40, 3072
  s_add_u32 s79, s79, 114944
  v_lshl_add_u32 v68, v1, 2, s79
  v_lshrrev_b32 v66, 4, v1
  v_and_b32 v67, 7, v1
  v_bfe_u32 v69, v1, 3, 1
  v_lshlrev_b32 v70, 8, v66
  v_lshl_add_u32 v70, v67, 5, v70
  v_lshl_add_u32 v70, v69, 4, v70
  v_add_u32 v70, s79, v70
  v_lshlrev_b32 v66, 10, v66
  v_lshl_add_u32 v66, v67, 4, v66
  v_lshl_add_u32 v66, v69, 9, v66
  s_mul_i32 s73, s78, 3072
  s_sub_u32 s73, 43008, s73
  v_lshrrev_b32 v67, 5, v1
  v_mul_u32_u24 v67, s73, v67
  v_add_u32 v67, v66, v67
  v_lshrrev_b32 v71, 4, v1
  v_min_u32 v71, 1, v71
  v_mul_u32_u24 v71, 21504, v71
  v_add_u32 v71, v66, v71
  s_lshl_b32 s79, s41, 2
  s_lshr_b32 s76, s77, 2
  s_add_u32 s79, s79, s76
  s_lshl_b32 s79, s79, 1
  s_add_u32 s79, s79, s40
  s_mul_i32 s79, s79, 98304
  s_mul_i32 s76, s78, 6144
  s_add_u32 s79, s79, s76
  s_and_b32 s76, s77, 3
  s_lshl_b32 s76, s76, 7
  s_add_u32 s79, s79, s76
  s_add_u32 s79, s79, 0x100000
  s_add_u32 s77, s79, 4096
  s_add_u32 s78, s79, 8192
  s_add_u32 s78, s78, s73
  s_mov_b32 s75, 0xbf317218
  s_mov_b32 s76, 0xbeb17218
  s_waitcnt vmcnt(0)
  v_lshlrev_b32 v172, 16, v160
  v_and_b32 v173, s56, v160
  v_lshlrev_b32 v174, 16, v161
  v_and_b32 v175, s56, v161
  v_lshlrev_b32 v176, 16, v162
  v_and_b32 v177, s56, v162
  v_lshlrev_b32 v178, 16, v164
  v_and_b32 v179, s56, v164
  v_lshlrev_b32 v180, 16, v165
  v_and_b32 v181, s56, v165
  v_lshlrev_b32 v182, 16, v166
  v_and_b32 v183, s56, v166
  v_lshlrev_b32 v184, 16, v168
  v_and_b32 v185, s56, v168
  v_lshlrev_b32 v186, 16, v169
  v_and_b32 v187, s56, v169
  v_lshlrev_b32 v188, 16, v170
  v_and_b32 v189, s56, v170
  v_add_f32 v190, v172, v178
  v_add_f32 v191, v173, v179
  v_add_f32 v192, v174, v180
  v_add_f32 v193, v181, v187
  v_add_f32 v194, v182, v188
  v_add_f32 v195, v183, v189
  v_add_f32 v196, v190, v175
  v_sub_f32 v202, v190, v175
  v_add_f32 v197, v191, v176
  v_sub_f32 v203, v191, v176
  v_add_f32 v198, v192, v177
  v_sub_f32 v204, v192, v177
  v_add_f32 v199, v193, v184
  v_sub_f32 v205, v193, v184
  v_add_f32 v200, v194, v185
  v_sub_f32 v206, v194, v185
  v_add_f32 v201, v195, v186
  v_sub_f32 v207, v195, v186
  v_mul_f32 v196, s76, v196
  v_mul_f32 v197, s76, v197
  v_mul_f32 v198, s76, v198
  v_mul_f32 v199, s76, v199
  v_mul_f32 v200, s76, v200
  v_mul_f32 v201, s76, v201
  v_mul_f32 v202, s76, v202
  v_mul_f32 v203, s76, v203
  v_mul_f32 v204, s76, v204
  v_mul_f32 v205, s76, v205
  v_mul_f32 v206, s76, v206
  v_mul_f32 v207, s76, v207
  v_mul_f32 v172, s75, v172
  v_mul_f32 v173, s75, v173
  v_mul_f32 v174, s75, v174
  v_mul_f32 v178, s75, v178
  v_mul_f32 v179, s75, v179
  v_mul_f32 v180, s75, v180
  v_mul_f32 v181, s75, v181
  v_mul_f32 v182, s75, v182
  v_mul_f32 v183, s75, v183
  v_mul_f32 v187, s75, v187
  v_mul_f32 v188, s75, v188
  v_mul_f32 v189, s75, v189
  v_cvt_pk_bf16_f32 v208, v196, v199
  v_cvt_pk_bf16_f32 v211, v202, v205
  v_cvt_pk_bf16_f32 v214, v172, v181
  v_cvt_pk_bf16_f32 v217, v178, v187
  v_cvt_pk_bf16_f32 v209, v197, v200
  v_cvt_pk_bf16_f32 v212, v203, v206
  v_cvt_pk_bf16_f32 v215, v173, v182
  v_cvt_pk_bf16_f32 v218, v179, v188
  v_cvt_pk_bf16_f32 v210, v198, v201
  v_cvt_pk_bf16_f32 v213, v204, v207
  v_cvt_pk_bf16_f32 v216, v174, v183
  v_cvt_pk_bf16_f32 v219, v180, v189
  ds_write_b32 v68, v208 offset:0
  ds_write_b32 v68, v209 offset:256
  ds_write_b32 v68, v210 offset:512
  ds_write_b32 v68, v211 offset:768
  ds_write_b32 v68, v212 offset:1024
  ds_write_b32 v68, v213 offset:1280
  ds_write_b32 v68, v214 offset:1536
  ds_write_b32 v68, v215 offset:1792
  ds_write_b32 v68, v216 offset:2048
  ds_write_b32 v68, v217 offset:2304
  ds_write_b32 v68, v218 offset:2560
  ds_write_b32 v68, v219 offset:2816
  s_waitcnt lgkmcnt(0)
  ds_read_b128 v[160:163], v70 offset:0
  ds_read_b128 v[164:167], v70 offset:1024
  ds_read_b128 v[168:171], v70 offset:2048
  s_waitcnt lgkmcnt(0)
  buffer_store_dwordx4 v[160:163], v66, s[32:35], s79 offen sc1
  buffer_store_dwordx4 v[164:167], v67, s[32:35], s77 offen sc1
  buffer_store_dwordx4 v[168:171], v71, s[32:35], s78 offen sc1
  s_barrier
  s_branch L_mjoin
L_m23:
  s_cmp_eq_u32 s40, 2
  s_cbranch_scc0 L_m3
  s_lshr_b32 s77, s44, 4
  s_and_b32 s78, s44, 15
  v_min_u32 v9, 47, v1
  s_mul_i32 s75, s41, 1536
  s_mul_i32 s76, s77, 192
  s_add_u32 s75, s75, s76
  v_lshl_add_u32 v15, v9, 2, s75
  s_mul_i32 s75, s77, 24576
  s_lshl_b32 s76, s78, 4
  s_add_u32 s75, s75, s76
  v_lshl_add_u32 v3, v9, 9, s75
  s_barrier
  global_load_dword v160, v15, s[6:7]
  global_load_dwordx4 v[164:167], v3, s[14:15]
  global_load_dwordx4 v[168:171], v3, s[14:15] offset:256
  s_branch L_mjoin
L_m3:
  v_lshlrev_b32 v2, 2, v1
  s_barrier
  global_load_dword v160, v2, s[8:9]
  global_load_dword v161, v2, s[10:11]
  global_load_dword v162, v2, s[16:17]
  global_load_dword v163, v2, s[18:19]
  s_getpc_b64 s[80:81]
L_pc:
  s_mul_i32 s75, s47, 640
  v_min_u32 v9, 4, v1
  v_lshl_add_u32 v9, v9, 7, s75
  v_min_u32 v9, (L_end-L_pc)&0xfffffffc, v9
  s_lshl_b32 s75, s45, 7
  s_add_u32 s75, s75, 0x10000
  v_lshlrev_b32 v2, 16, v1
  s_mov_b64 exec, 3
  buffer_store_dword v1, v2, s[32:35], s75 offen offset:12 sc1
  s_mov_b64 exec, -1
  global_load_dword v176, v9, s[80:81]
L_mjoin:
  s_and_b32 s75, s40, 1
  s_lshl_b32 s75, s75, 6
  v_add_u32 v9, s75, v1
  v_lshlrev_b32 v14, 1, v9
  s_cmp_ge_u32 s40, 2
  s_cselect_b32 s76, 3, 0
  s_cmp_eq_u32 s43, s76
  s_cselect_b32 s59, 0x7f800000, 1.0
  v_and_b32 v9, 31, v1
  v_lshrrev_b32 v13, 5, v1
  v_bfe_u32 v2, v9, 2, 1
  v_lshlrev_b32 v2, 4, v2
  v_lshrrev_b32 v15, 3, v9
  v_lshl_add_u32 v2, v15, 2, v2
  v_and_b32 v15, 3, v9
  v_add_u32 v15, v2, v15
  v_mul_u32_u24 v2, 272, v15
  v_lshl_add_u32 v2, v13, 4, v2
  s_lshl_b32 s75, s40, 5
  v_add_u32 v9, s75, v9
  v_lshlrev_b32 v15, 3, v9
  v_lshl_add_u32 v15, v13, 12, v15
  v_lshlrev_b32 v12, 4, v9
  v_lshl_add_u32 v12, v13, 11, v12
  v_mul_u32_u24 v3, 80, v9
  v_lshl_add_u32 v3, v13, 5, v3
  v_add_u32 v3, 114944, v3
  s_cmp_ge_u32 s40, 2
  s_cselect_b32 s75, 8976, 0
  v_add_u32 v5, s75, v14
  s_cmp_eq_u32 s59, 1.0
  s_cselect_b32 s75, s57, s59
  s_cselect_b32 s76, s58, s59
  v_mov_b32 v6, s75
  v_mov_b32 v7, s59
  v_mov_b32 v8, s76
  v_lshlrev_b32 v9, 3, v14
  v_lshlrev_b32 v13, 1, v14
  v_add_u32 v13, 156416, v13
  v_lshrrev_b32 v14, 6, v14
  v_lshlrev_b32 v14, 3, v14
  v_add_u32 v14, 155968, v14
  v_and_b32 v122, 7, v1
  v_lshlrev_b32 v122, 2, v122
  v_add_u32 v122, 156032, v122
  s_lshl_b32 s75, s40, 2
  s_add_u32 s75, s75, 156048
  v_mov_b32 v123, s75
  v_mov_b32 v124, 0
  s_mov_b32 s12, 1
  v_mov_b32 v64, 0
  v_lshlrev_b32 v65, 2, v1
  v_add_u32 v65, 155968, v65
  ds_write_b32 v65, v64
  s_cmp_ge_u32 s40, 2
  s_mov_b32 s71, -30720
  s_cselect_b32 s71, 32768, s71
  s_cmp_eq_u32 s59, 1.0
  s_cselect_b32 s71, s71, 0
  s_add_u32 s6, s3, s71
  s_add_u32 s6, s6, 28672
  s_cmp_eq_u32 s42, 0
  s_cselect_b32 s71, 0, 131072
  s_sub_u32 s7, s6, s71
  s_cmp_eq_u32 s42, 31
  s_cselect_b32 s71, 0, 131072
  s_add_u32 s8, s6, s71
  s_lshl_b32 s5, s41, 13
  s_add_u32 s5, s5, 0x9000
  s_lshl_b32 s68, s41, 2
  s_add_u32 s68, s68, s40
  s_mul_i32 s68, s68, 196608
  s_add_u32 s68, s68, 0x100000
  s_lshr_b32 s9, s47, 3
  s_lshl_b32 s74, s41, 2
  s_add_u32 s9, s9, s74
  s_mul_i32 s9, s9, 196608
  s_and_b32 s74, s47, 7
  s_mul_i32 s74, s74, 12288
  s_add_u32 s9, s9, s74
  s_mul_i32 s74, s40, 3072
  s_add_u32 s9, s9, s74
  s_add_u32 s9, s9, 0x100000
  s_mul_i32 s10, s40, 10240
  s_add_u32 s10, s10, 114944
  v_add_u32 v126, s10, v4
  v_min_u32 v127, 23, v1
  v_lshlrev_b32 v127, 7, v127
  v_mov_b64 v[128:129], 0
  v_mov_b64 v[130:131], 0
  v_mov_b64 v[132:133], 0
  v_mov_b64 v[134:135], 0
  v_mov_b64 v[136:137], 0
  v_mov_b64 v[138:139], 0
  v_mov_b64 v[140:141], 0
  v_mov_b64 v[142:143], 0
  v_mov_b64 v[144:145], 0
  v_mov_b64 v[146:147], 0
  v_mov_b64 v[148:149], 0
  v_mov_b64 v[150:151], 0
  v_mov_b64 v[152:153], 0
  v_mov_b64 v[154:155], 0
  v_mov_b64 v[156:157], 0
  v_mov_b64 v[158:159], 0
  v_mov_b64 v[224:225], 0
  v_mov_b64 v[226:227], 0
  v_mov_b64 v[228:229], 0
  v_mov_b64 v[230:231], 0
  v_mov_b64 v[232:233], 0
  v_mov_b64 v[234:235], 0
  v_mov_b64 v[236:237], 0
  v_mov_b64 v[238:239], 0
  v_mov_b64 v[240:241], 0
  v_mov_b64 v[242:243], 0
  v_mov_b64 v[244:245], 0
  v_mov_b64 v[246:247], 0
  v_mov_b64 v[248:249], 0
  v_mov_b64 v[250:251], 0
  v_mov_b64 v[252:253], 0
  v_mov_b64 v[254:255], 0
  s_cmp_ge_u32 s40, 1
  s_cbranch_scc1 L_m_nowait
  s_waitcnt vmcnt(0)
L_m_nowait:
  s_waitcnt lgkmcnt(0)
  s_mul_i32 s46, s46, 0x9e3779b1
  s_add_u32 s46, s46, 0x7f4a7c15
  s_lshl_b32 s4, s41, 14
  s_add_u32 s4, s4, 0x10000
  s_barrier
  s_cmp_eq_u32 s40, 3
  s_cbranch_scc0 L_m_post
  s_waitcnt vmcnt(0)
  v_lshlrev_b32 v11, 3, v1
  v_add_u32 v11, 156416, v11
  v_lshlrev_b32 v164, 16, v160
  v_and_b32 v165, s56, v160
  v_mul_f32 v164, s54, v164
  v_mul_f32 v165, s54, v165
  ds_write_b64 v11, v[164:165] offset:0
  v_lshlrev_b32 v166, 16, v161
  v_and_b32 v167, s56, v161
  v_mul_f32 v166, s54, v166
  v_mul_f32 v167, s54, v167
  ds_write_b64 v11, v[166:167] offset:512
  v_lshlrev_b32 v168, 16, v162
  v_and_b32 v169, s56, v162
  v_mul_f32 v168, s54, v168
  v_mul_f32 v169, s54, v169
  ds_write_b64 v11, v[168:169] offset:1024
  v_lshlrev_b32 v170, 16, v163
  v_and_b32 v171, s56, v163
  v_mul_f32 v170, s54, v170
  v_mul_f32 v171, s54, v171
  ds_write_b64 v11, v[170:171] offset:1536
L_m_post:
  v_add_u32 v11, 2048, v13
  v_mov_b32 v104, v13
  s_cmp_eq_u32 s40, 1
  s_cbranch_scc0 L_m_nou2
  s_lshr_b32 s77, s44, 3
  s_and_b32 s78, s44, 7
  s_mul_i32 s79, s40, 3072
  s_add_u32 s79, s79, 114944
  v_lshl_add_u32 v68, v1, 2, s79
  v_lshrrev_b32 v66, 4, v1
  v_and_b32 v67, 7, v1
  v_bfe_u32 v69, v1, 3, 1
  v_lshlrev_b32 v70, 8, v66
  v_lshl_add_u32 v70, v67, 5, v70
  v_lshl_add_u32 v70, v69, 4, v70
  v_add_u32 v70, s79, v70
  v_lshlrev_b32 v66, 10, v66
  v_lshl_add_u32 v66, v67, 4, v66
  v_lshl_add_u32 v66, v69, 9, v66
  s_mul_i32 s73, s78, 3072
  s_sub_u32 s73, 43008, s73
  v_lshrrev_b32 v67, 5, v1
  v_mul_u32_u24 v67, s73, v67
  v_add_u32 v67, v66, v67
  v_lshrrev_b32 v71, 4, v1
  v_min_u32 v71, 1, v71
  v_mul_u32_u24 v71, 21504, v71
  v_add_u32 v71, v66, v71
  s_lshl_b32 s79, s41, 2
  s_lshr_b32 s76, s77, 2
  s_add_u32 s79, s79, s76
  s_lshl_b32 s79, s79, 1
  s_add_u32 s79, s79, s40
  s_mul_i32 s79, s79, 98304
  s_mul_i32 s76, s78, 6144
  s_add_u32 s79, s79, s76
  s_and_b32 s76, s77, 3
  s_lshl_b32 s76, s76, 7
  s_add_u32 s79, s79, s76
  s_add_u32 s79, s79, 0x100000
  s_add_u32 s77, s79, 4096
  s_add_u32 s78, s79, 8192
  s_add_u32 s78, s78, s73
  s_mov_b32 s75, 0xbf317218
  s_mov_b32 s76, 0xbeb17218
  s_waitcnt vmcnt(0)
  v_lshlrev_b32 v172, 16, v160
  v_and_b32 v173, s56, v160
  v_lshlrev_b32 v174, 16, v161
  v_and_b32 v175, s56, v161
  v_lshlrev_b32 v176, 16, v162
  v_and_b32 v177, s56, v162
  v_lshlrev_b32 v178, 16, v164
  v_and_b32 v179, s56, v164
  v_lshlrev_b32 v180, 16, v165
  v_and_b32 v181, s56, v165
  v_lshlrev_b32 v182, 16, v166
  v_and_b32 v183, s56, v166
  v_lshlrev_b32 v184, 16, v168
  v_and_b32 v185, s56, v168
  v_lshlrev_b32 v186, 16, v169
  v_and_b32 v187, s56, v169
  v_lshlrev_b32 v188, 16, v170
  v_and_b32 v189, s56, v170
  v_add_f32 v190, v172, v178
  v_add_f32 v191, v173, v179
  v_add_f32 v192, v174, v180
  v_add_f32 v193, v181, v187
  v_add_f32 v194, v182, v188
  v_add_f32 v195, v183, v189
  v_add_f32 v196, v190, v175
  v_sub_f32 v202, v190, v175
  v_add_f32 v197, v191, v176
  v_sub_f32 v203, v191, v176
  v_add_f32 v198, v192, v177
  v_sub_f32 v204, v192, v177
  v_add_f32 v199, v193, v184
  v_sub_f32 v205, v193, v184
  v_add_f32 v200, v194, v185
  v_sub_f32 v206, v194, v185
  v_add_f32 v201, v195, v186
  v_sub_f32 v207, v195, v186
  v_mul_f32 v196, s76, v196
  v_mul_f32 v197, s76, v197
  v_mul_f32 v198, s76, v198
  v_mul_f32 v199, s76, v199
  v_mul_f32 v200, s76, v200
  v_mul_f32 v201, s76, v201
  v_mul_f32 v202, s76, v202
  v_mul_f32 v203, s76, v203
  v_mul_f32 v204, s76, v204
  v_mul_f32 v205, s76, v205
  v_mul_f32 v206, s76, v206
  v_mul_f32 v207, s76, v207
  v_mul_f32 v172, s75, v172
  v_mul_f32 v173, s75, v173
  v_mul_f32 v174, s75, v174
  v_mul_f32 v178, s75, v178
  v_mul_f32 v179, s75, v179
  v_mul_f32 v180, s75, v180
  v_mul_f32 v181, s75, v181
  v_mul_f32 v182, s75, v182
  v_mul_f32 v183, s75, v183
  v_mul_f32 v187, s75, v187
  v_mul_f32 v188, s75, v188
  v_mul_f32 v189, s75, v189
  v_cvt_pk_bf16_f32 v208, v196, v199
  v_cvt_pk_bf16_f32 v211, v202, v205
  v_cvt_pk_bf16_f32 v214, v172, v181
  v_cvt_pk_bf16_f32 v217, v178, v187
  v_cvt_pk_bf16_f32 v209, v197, v200
  v_cvt_pk_bf16_f32 v212, v203, v206
  v_cvt_pk_bf16_f32 v215, v173, v182
  v_cvt_pk_bf16_f32 v218, v179, v188
  v_cvt_pk_bf16_f32 v210, v198, v201
  v_cvt_pk_bf16_f32 v213, v204, v207
  v_cvt_pk_bf16_f32 v216, v174, v183
  v_cvt_pk_bf16_f32 v219, v180, v189
  ds_write_b32 v68, v208 offset:0
  ds_write_b32 v68, v209 offset:256
  ds_write_b32 v68, v210 offset:512
  ds_write_b32 v68, v211 offset:768
  ds_write_b32 v68, v212 offset:1024
  ds_write_b32 v68, v213 offset:1280
  ds_write_b32 v68, v214 offset:1536
  ds_write_b32 v68, v215 offset:1792
  ds_write_b32 v68, v216 offset:2048
  ds_write_b32 v68, v217 offset:2304
  ds_write_b32 v68, v218 offset:2560
  ds_write_b32 v68, v219 offset:2816
  s_waitcnt lgkmcnt(0)
  ds_read_b128 v[160:163], v70 offset:0
  ds_read_b128 v[164:167], v70 offset:1024
  ds_read_b128 v[168:171], v70 offset:2048
  s_waitcnt lgkmcnt(0)
  buffer_store_dwordx4 v[160:163], v66, s[32:35], s79 offen sc1
  buffer_store_dwordx4 v[164:167], v67, s[32:35], s77 offen sc1
  buffer_store_dwordx4 v[168:171], v71, s[32:35], s78 offen sc1
L_m_nou2:
  s_cmp_eq_u32 s40, 2
  s_cbranch_scc0 L_m_noemb
  s_waitcnt vmcnt(0)
  v_cmp_gt_u32 vcc, 48, v1
  v_and_b32 v13, 48, v1
  s_lshl_b32 s79, s41, 13
  s_lshl_b32 s76, s44, 6
  s_add_u32 s79, s79, s76
  s_add_u32 s79, s79, 0x9000
  v_cndmask_b32 v160, 0, v160, vcc
  v_lshlrev_b32 v161, 16, v160
  v_and_b32 v162, s56, v160
  v_mul_f32 v188, s54, v161
  v_mul_f32 v189, s54, v162
  v_exp_f32 v188, v188
  v_exp_f32 v189, v189
  v_lshlrev_b32 v172, 16, v164
  v_and_b32 v173, s56, v164
  v_lshlrev_b32 v174, 16, v165
  v_and_b32 v175, s56, v165
  v_lshlrev_b32 v176, 16, v166
  v_and_b32 v177, s56, v166
  v_lshlrev_b32 v178, 16, v167
  v_and_b32 v179, s56, v167
  v_add_f32 v188, 1.0, v188
  v_add_f32 v189, 1.0, v189
  v_rcp_f32 v188, v188
  v_rcp_f32 v189, v189
  v_lshlrev_b32 v180, 16, v168
  v_and_b32 v181, s56, v168
  v_lshlrev_b32 v182, 16, v169
  v_and_b32 v183, s56, v169
  v_lshlrev_b32 v184, 16, v170
  v_and_b32 v185, s56, v170
  v_lshlrev_b32 v186, 16, v171
  v_and_b32 v187, s56, v171
  v_mul_f32 v161, v161, v188
  v_mul_f32 v162, v162, v189
  v_cvt_pk_bf16_f32 v160, v161, v162
  v_lshlrev_b32 v161, 16, v160
  v_and_b32 v162, s56, v160
  v_mul_f32 v188, v161, v172
  v_mul_f32 v189, v161, v173
  v_mul_f32 v190, v161, v174
  v_mul_f32 v191, v161, v175
  v_mul_f32 v192, v161, v176
  v_mul_f32 v193, v161, v177
  v_mul_f32 v194, v161, v178
  v_mul_f32 v195, v161, v179
  v_fmac_f32 v188, v162, v180
  v_fmac_f32 v189, v162, v181
  v_fmac_f32 v190, v162, v182
  v_fmac_f32 v191, v162, v183
  v_fmac_f32 v192, v162, v184
  v_fmac_f32 v193, v162, v185
  v_fmac_f32 v194, v162, v186
  v_fmac_f32 v195, v162, v187
  s_nop 1
  v_permlane32_swap_b32 v188, v192
  v_permlane32_swap_b32 v189, v193
  v_permlane32_swap_b32 v190, v194
  v_permlane32_swap_b32 v191, v195
  v_add_f32 v188, v188, v192
  v_add_f32 v189, v189, v193
  v_add_f32 v190, v190, v194
  v_add_f32 v191, v191, v195
  s_nop 1
  v_permlane16_swap_b32 v188, v190
  v_permlane16_swap_b32 v189, v191
  s_nop 0
  v_add_f32 v188, v188, v190
  v_add_f32 v189, v189, v191
  s_nop 0
  v_add_f32_dpp v188, v188, v188 row_ror:8 row_mask:0xf bank_mask:0xf
  v_add_f32_dpp v189, v189, v189 row_ror:8 row_mask:0xf bank_mask:0xf
  s_nop 0
  v_add_f32_dpp v188, v188, v188 row_ror:4 row_mask:0xf bank_mask:0xf
  v_add_f32_dpp v189, v189, v189 row_ror:4 row_mask:0xf bank_mask:0xf
  s_nop 0
  v_add_f32_dpp v188, v188, v188 row_ror:2 row_mask:0xf bank_mask:0xf
  v_add_f32_dpp v189, v189, v189 row_ror:2 row_mask:0xf bank_mask:0xf
  s_nop 0
  v_add_f32_dpp v188, v188, v188 row_ror:1 row_mask:0xf bank_mask:0xf
  v_add_f32_dpp v189, v189, v189 row_ror:1 row_mask:0xf bank_mask:0xf
  s_nop 0
  v_mov_b32 v190, v189
  v_mov_b32 v189, s46
  v_mov_b32 v191, s46
L_m_noemb:
L_mconv:
  s_waitcnt lgkmcnt(0)
  s_barrier
  ds_read2st64_b32 v[102:103], v104 offset0:0 offset1:2
  ds_read_b64 v[106:107], v14
  buffer_load_dwordx4 v[110:113], v9, s[32:35], s6 offen sc1
  buffer_load_dwordx4 v[114:117], v9, s[32:35], s7 offen sc1
  buffer_load_dwordx4 v[118:121], v9, s[32:35], s8 offen sc1
  s_cmp_eq_u32 s25, 0
  s_cbranch_scc0 L_oc_1
  buffer_load_dword v127, v127, s[32:35], s9 offen sc1
  buffer_load_dwordx4 v[16:19], v4, s[32:35], s68 offen offset:0 sc1
  buffer_load_dwordx4 v[20:23], v4, s[32:35], s68 offen offset:1024 sc1
  buffer_load_dwordx4 v[24:27], v4, s[32:35], s68 offen offset:2048 sc1
  buffer_load_dwordx4 v[28:31], v4, s[32:35], s68 offen offset:3072 sc1
  s_add_u32 s68, s68, 4096
L_oc_1:
  s_waitcnt lgkmcnt(0)
  v_mul_f32 v106, 0x36000000, v106
  v_mul_f32 v107, 0x36000000, v107
  v_fma_f32 v107, -v106, v106, v107
  v_max_f32 v107, 0, v107
  v_add_f32 v107, 0x3727c5ac, v107
  v_rsq_f32 v107, v107
  s_nop 0
  v_mul_f32 v107, v107, v102
  v_fma_f32 v106, -v107, v106, v103
  ds_write2st64_b32 v11, v107, v106 offset0:0 offset1:2
  v_add_u32 v124, 8, v124
  s_mov_b64 exec, 1
  ds_write2_b32 v123, v124, v124 offset0:4 offset1:8
  s_mov_b64 exec, -1
  s_mov_b32 s69, 0
  s_cmp_eq_u32 s25, 0
  s_cbranch_scc0 L_cchk1
  s_waitcnt vmcnt(5)
  s_branch L_cchk2
L_cchk1:
  s_waitcnt vmcnt(0)
  s_branch L_cchk2
L_cchk:
  s_waitcnt vmcnt(0)
L_cchk2:
  v_cmp_eq_u32 vcc, s46, v112
  v_cmp_eq_u32 s[80:81], s46, v116
  s_and_b64 vcc, vcc, s[80:81]
  v_cmp_eq_u32 s[80:81], s46, v120
  s_and_b64 vcc, vcc, s[80:81]
  s_cmp_eq_u64 vcc, -1
  s_cbranch_scc1 L_cok
  s_add_u32 s69, s69, 1
  s_cmp_ge_u32 s69, 40000
  s_cbranch_scc1 L_cok
  buffer_load_dwordx4 v[110:113], v9, s[32:35], s6 offen sc1
  buffer_load_dwordx4 v[114:117], v9, s[32:35], s7 offen sc1
  buffer_load_dwordx4 v[118:121], v9, s[32:35], s8 offen sc1
  s_branch L_cchk
L_cok:
  v_and_b32 v96, s56, v115
  v_lshlrev_b32 v97, 16, v110
  v_and_b32 v98, s56, v110
  v_lshlrev_b32 v99, 16, v111
  v_and_b32 v100, s56, v111
  v_lshlrev_b32 v101, 16, v118
.p2align 3
  v_fma_f32 v96, v96, v107, v106
  v_fma_f32 v97, v97, v107, v106
  v_fma_f32 v98, v98, v107, v106
  v_fma_f32 v99, v99, v107, v106
  v_fma_f32 v100, v100, v107, v106
  v_fma_f32 v101, v101, v107, v106
  v_exp_f32 v108, v96
  v_exp_f32 v109, v97
  v_exp_f32 v110, v98
  v_exp_f32 v111, v99
  v_exp_f32 v112, v100
  v_exp_f32 v113, v101
  v_add_f32 v108, v108, v6
  v_add_f32 v109, v109, v7
  v_add_f32 v110, v110, v7
  v_add_f32 v111, v111, v7
  v_add_f32 v112, v112, v7
  v_add_f32 v113, v113, v8
  v_rcp_f32 v108, v108
  v_rcp_f32 v109, v109
  v_rcp_f32 v110, v110
  v_rcp_f32 v111, v111
  v_rcp_f32 v112, v112
  v_rcp_f32 v113, v113
  v_mul_f32 v110, v98, v110
  v_mul_f32 v111, v99, v111
  v_fma_f32 v114, v96, v108, -v110
  v_fma_f32 v115, v97, v109, v110
  v_fma_f32 v116, -v97, v109, v110
  v_fma_f32 v117, -v97, v109, v111
  v_fma_f32 v118, -v100, v112, v110
  v_fma_f32 v119, v100, v112, v111
  v_fma_f32 v120, v100, v112, -v111
  v_fma_f32 v121, v101, v113, -v111
  v_cvt_pk_bf16_f32 v108, v114, v115
  v_cvt_pk_bf16_f32 v109, v116, v117
  v_cvt_pk_bf16_f32 v110, v118, v119
  v_cvt_pk_bf16_f32 v111, v120, v121
  ds_write_b16 v5, v108 offset:0
  ds_write_b16_d16_hi v5, v108 offset:9248
  ds_write_b16 v5, v109 offset:18496
  ds_write_b16_d16_hi v5, v109 offset:27744
  ds_write_b16 v5, v110 offset:36992
  ds_write_b16_d16_hi v5, v110 offset:46240
  ds_write_b16 v5, v111 offset:55488
  ds_write_b16_d16_hi v5, v111 offset:64736
  s_mov_b64 exec, 1
  ds_write_b32 v123, v124
  s_mov_b64 exec, -1
  s_cmp_eq_u32 s25, 0
  s_cbranch_scc0 L_oc_2
  buffer_load_dwordx4 v[32:35], v4, s[32:35], s68 offen offset:0 sc1
  buffer_load_dwordx4 v[36:39], v4, s[32:35], s68 offen offset:1024 sc1
  buffer_load_dwordx4 v[40:43], v4, s[32:35], s68 offen offset:2048 sc1
  buffer_load_dwordx4 v[44:47], v4, s[32:35], s68 offen offset:3072 sc1
  s_add_u32 s68, s68, 4096
  buffer_load_dwordx4 v[48:51], v4, s[32:35], s68 offen offset:0 sc1
  buffer_load_dwordx4 v[52:55], v4, s[32:35], s68 offen offset:1024 sc1
  buffer_load_dwordx4 v[56:59], v4, s[32:35], s68 offen offset:2048 sc1
  buffer_load_dwordx4 v[60:63], v4, s[32:35], s68 offen offset:3072 sc1
  s_add_u32 s68, s68, 4096
L_oc_2:
L_psp_4:
  ds_read_b32 v125, v122 offset:0
  s_waitcnt lgkmcnt(0)
  v_cmp_le_u32 vcc, s12, v125
  s_cmp_eq_u64 vcc, -1
  s_cbranch_scc0 L_psp_4
L_pok_3:
  s_add_u32 s12, s12, 1
  s_lshl_b32 s75, s25, 2
  s_add_u32 s75, s75, s40
  s_cmp_eq_u32 s75, 2
  s_cbranch_scc0 L_m_noembst
  s_mov_b32 exec_lo, 0x10001
  s_mov_b32 exec_hi, 0x10001
  buffer_store_dwordx4 v[188:191], v13, s[32:35], s79 offen sc1
  s_mov_b64 exec, -1
L_m_noembst:
  ds_read_b128 v[64:67], v2 offset:9248
  ds_read_b128 v[68:71], v2 offset:46240
  ds_read_b128 v[72:75], v2 offset:9520
  ds_read_b128 v[76:79], v2 offset:46512
  ds_read_b128 v[80:83], v2 offset:9792
  ds_read_b128 v[84:87], v2 offset:46784
  s_waitcnt vmcnt(11) lgkmcnt(5)
  v_mfma_f32_32x32x16_bf16 v[160:175], v[64:67], v[16:19], 0
  ds_read_b128 v[88:91], v2 offset:18496
  s_waitcnt lgkmcnt(5)
  v_mfma_f32_32x32x16_bf16 v[176:191], v[68:71], v[16:19], 0
  ds_read_b128 v[92:95], v2 offset:55488
  buffer_load_dwordx4 v[16:19], v4, s[32:35], s68 offen offset:0 sc1
  s_waitcnt vmcnt(11) lgkmcnt(5)
  v_mfma_f32_32x32x16_bf16 v[160:175], v[72:75], v[20:23], v[160:175]
  ds_read_b128 v[64:67], v2 offset:18768
  s_waitcnt lgkmcnt(5)
  v_mfma_f32_32x32x16_bf16 v[176:191], v[76:79], v[20:23], v[176:191]
  ds_read_b128 v[68:71], v2 offset:55760
  buffer_load_dwordx4 v[20:23], v4, s[32:35], s68 offen offset:1024 sc1
  s_waitcnt vmcnt(11) lgkmcnt(5)
  v_mfma_f32_32x32x16_bf16 v[160:175], v[80:83], v[24:27], v[160:175]
  ds_read_b128 v[72:75], v2 offset:19040
  s_waitcnt lgkmcnt(5)
  v_mfma_f32_32x32x16_bf16 v[176:191], v[84:87], v[24:27], v[176:191]
  ds_read_b128 v[76:79], v2 offset:56032
  buffer_load_dwordx4 v[24:27], v4, s[32:35], s68 offen offset:2048 sc1
  s_waitcnt vmcnt(11) lgkmcnt(5)
  v_mfma_f32_32x32x16_bf16 v[192:207], v[88:91], v[28:31], 0
  ds_read_b128 v[80:83], v2 offset:9280
  s_waitcnt lgkmcnt(5)
  v_mfma_f32_32x32x16_bf16 v[208:223], v[92:95], v[28:31], 0
  ds_read_b128 v[84:87], v2 offset:46272
  buffer_load_dwordx4 v[28:31], v4, s[32:35], s68 offen offset:3072 sc1
  s_add_u32 s68, s68, 4096
  s_waitcnt vmcnt(11) lgkmcnt(5)
  v_mfma_f32_32x32x16_bf16 v[192:207], v[64:67], v[32:35], v[192:207]
  ds_read_b128 v[88:91], v2 offset:9552
  s_waitcnt lgkmcnt(5)
  v_mfma_f32_32x32x16_bf16 v[208:223], v[68:71], v[32:35], v[208:223]
  ds_read_b128 v[92:95], v2 offset:46544
  buffer_load_dwordx4 v[32:35], v4, s[32:35], s68 offen offset:0 sc1
  s_waitcnt vmcnt(11) lgkmcnt(5)
  v_mfma_f32_32x32x16_bf16 v[192:207], v[72:75], v[36:39], v[192:207]
  ds_read_b128 v[64:67], v2 offset:9824
  s_waitcnt lgkmcnt(5)
  v_mfma_f32_32x32x16_bf16 v[208:223], v[76:79], v[36:39], v[208:223]
  ds_read_b128 v[68:71], v2 offset:46816
  buffer_load_dwordx4 v[36:39], v4, s[32:35], s68 offen offset:1024 sc1
  s_waitcnt vmcnt(11) lgkmcnt(5)
  v_mfma_f32_32x32x16_bf16 v[160:175], v[80:83], v[40:43], v[160:175]
  ds_read_b128 v[72:75], v2 offset:18528
  s_waitcnt lgkmcnt(5)
  v_mfma_f32_32x32x16_bf16 v[176:191], v[84:87], v[40:43], v[176:191]
  ds_read_b128 v[76:79], v2 offset:55520
  buffer_load_dwordx4 v[40:43], v4, s[32:35], s68 offen offset:2048 sc1
  s_waitcnt vmcnt(11) lgkmcnt(5)
  v_mfma_f32_32x32x16_bf16 v[160:175], v[88:91], v[44:47], v[160:175]
  ds_read_b128 v[80:83], v2 offset:18800
  s_waitcnt lgkmcnt(5)
  v_mfma_f32_32x32x16_bf16 v[176:191], v[92:95], v[44:47], v[176:191]
  ds_read_b32 v125, v122
  ds_read_b128 v[84:87], v2 offset:55792
  buffer_load_dwordx4 v[44:47], v4, s[32:35], s68 offen offset:3072 sc1
  s_add_u32 s68, s68, 4096
  s_waitcnt vmcnt(11) lgkmcnt(6)
  v_mfma_f32_32x32x16_bf16 v[160:175], v[64:67], v[48:51], v[160:175]
  ds_read_b128 v[88:91], v2 offset:19072
  s_waitcnt lgkmcnt(6)
  v_mfma_f32_32x32x16_bf16 v[176:191], v[68:71], v[48:51], v[176:191]
  ds_read_b128 v[92:95], v2 offset:56064
  buffer_load_dwordx4 v[48:51], v4, s[32:35], s68 offen offset:0 sc1
  s_waitcnt vmcnt(11) lgkmcnt(6)
  v_mfma_f32_32x32x16_bf16 v[192:207], v[72:75], v[52:55], v[192:207]
  s_waitcnt lgkmcnt(3)
  v_cmp_le_u32 vcc, s12, v125
  s_cmp_eq_u64 vcc, -1
  s_cbranch_scc1 L_pok_5
L_psp_6:
  ds_read_b32 v125, v122 offset:0
  s_waitcnt lgkmcnt(0)
  v_cmp_le_u32 vcc, s12, v125
  s_cmp_eq_u64 vcc, -1
  s_cbranch_scc0 L_psp_6
L_pok_5:
  s_add_u32 s12, s12, 1
  ds_read_b128 v[64:67], v2 offset:9312
  v_mfma_f32_32x32x16_bf16 v[208:223], v[76:79], v[52:55], v[208:223]
  ds_read_b128 v[68:71], v2 offset:46304
  buffer_load_dwordx4 v[52:55], v4, s[32:35], s68 offen offset:1024 sc1
  s_waitcnt vmcnt(11)
  v_mfma_f32_32x32x16_bf16 v[192:207], v[80:83], v[56:59], v[192:207]
  ds_read_b128 v[72:75], v2 offset:9584
  s_waitcnt lgkmcnt(5)
  v_mfma_f32_32x32x16_bf16 v[208:223], v[84:87], v[56:59], v[208:223]
  ds_read_b128 v[76:79], v2 offset:46576
  buffer_load_dwordx4 v[56:59], v4, s[32:35], s68 offen offset:2048 sc1
  s_waitcnt vmcnt(11) lgkmcnt(5)
  v_mfma_f32_32x32x16_bf16 v[192:207], v[88:91], v[60:63], v[192:207]
  ds_read_b128 v[80:83], v2 offset:9856
  s_waitcnt lgkmcnt(5)
  v_mfma_f32_32x32x16_bf16 v[208:223], v[92:95], v[60:63], v[208:223]
  ds_read_b128 v[84:87], v2 offset:46848
  buffer_load_dwordx4 v[60:63], v4, s[32:35], s68 offen offset:3072 sc1
  s_add_u32 s68, s68, 4096
  s_waitcnt vmcnt(11) lgkmcnt(5)
  v_mfma_f32_32x32x16_bf16 v[160:175], v[64:67], v[16:19], v[160:175]
  ds_read_b128 v[88:91], v2 offset:18560
  s_waitcnt lgkmcnt(5)
  v_mfma_f32_32x32x16_bf16 v[176:191], v[68:71], v[16:19], v[176:191]
  ds_read_b128 v[92:95], v2 offset:55552
  buffer_load_dwordx4 v[16:19], v4, s[32:35], s68 offen offset:0 sc1
  s_waitcnt vmcnt(11) lgkmcnt(5)
  v_mfma_f32_32x32x16_bf16 v[160:175], v[72:75], v[20:23], v[160:175]
  ds_read_b128 v[64:67], v2 offset:18832
  s_waitcnt lgkmcnt(5)
  v_mfma_f32_32x32x16_bf16 v[176:191], v[76:79], v[20:23], v[176:191]
  ds_read_b128 v[68:71], v2 offset:55824
  buffer_load_dwordx4 v[20:23], v4, s[32:35], s68 offen offset:1024 sc1
  s_waitcnt vmcnt(11) lgkmcnt(5)
  v_mfma_f32_32x32x16_bf16 v[160:175], v[80:83], v[24:27], v[160:175]
  ds_read_b128 v[72:75], v2 offset:19104
  s_waitcnt lgkmcnt(5)
  v_mfma_f32_32x32x16_bf16 v[176:191], v[84:87], v[24:27], v[176:191]
  ds_read_b128 v[76:79], v2 offset:56096
  buffer_load_dwordx4 v[24:27], v4, s[32:35], s68 offen offset:2048 sc1
  s_waitcnt vmcnt(11) lgkmcnt(5)
  v_mfma_f32_32x32x16_bf16 v[192:207], v[88:91], v[28:31], v[192:207]
  ds_read_b128 v[80:83], v2 offset:9344
  s_waitcnt lgkmcnt(5)
  v_mfma_f32_32x32x16_bf16 v[208:223], v[92:95], v[28:31], v[208:223]
  ds_read_b128 v[84:87], v2 offset:46336
  buffer_load_dwordx4 v[28:31], v4, s[32:35], s68 offen offset:3072 sc1
  s_add_u32 s68, s68, 4096
  s_waitcnt vmcnt(11) lgkmcnt(5)
  v_mfma_f32_32x32x16_bf16 v[192:207], v[64:67], v[32:35], v[192:207]
  ds_read_b128 v[88:91], v2 offset:9616
  s_waitcnt lgkmcnt(5)
  v_mfma_f32_32x32x16_bf16 v[208:223], v[68:71], v[32:35], v[208:223]
  ds_read_b128 v[92:95], v2 offset:46608
  buffer_load_dwordx4 v[32:35], v4, s[32:35], s68 offen offset:0 sc1
  s_waitcnt vmcnt(11) lgkmcnt(5)
  v_mfma_f32_32x32x16_bf16 v[192:207], v[72:75], v[36:39], v[192:207]
  ds_read_b128 v[64:67], v2 offset:9888
  s_waitcnt lgkmcnt(5)
  v_mfma_f32_32x32x16_bf16 v[208:223], v[76:79], v[36:39], v[208:223]
  ds_read_b128 v[68:71], v2 offset:46880
  buffer_load_dwordx4 v[36:39], v4, s[32:35], s68 offen offset:1024 sc1
  s_waitcnt vmcnt(11) lgkmcnt(5)
  v_mfma_f32_32x32x16_bf16 v[160:175], v[80:83], v[40:43], v[160:175]
  ds_read_b128 v[72:75], v2 offset:18592
  s_waitcnt lgkmcnt(5)
  v_mfma_f32_32x32x16_bf16 v[176:191], v[84:87], v[40:43], v[176:191]
  ds_read_b128 v[76:79], v2 offset:55584
  buffer_load_dwordx4 v[40:43], v4, s[32:35], s68 offen offset:2048 sc1
  s_waitcnt vmcnt(11) lgkmcnt(5)
  v_mfma_f32_32x32x16_bf16 v[160:175], v[88:91], v[44:47], v[160:175]
  ds_read_b128 v[80:83], v2 offset:18864
  s_waitcnt lgkmcnt(5)
  v_mfma_f32_32x32x16_bf16 v[176:191], v[92:95], v[44:47], v[176:191]
  ds_read_b32 v125, v122
  ds_read_b128 v[84:87], v2 offset:55856
  buffer_load_dwordx4 v[44:47], v4, s[32:35], s68 offen offset:3072 sc1
  s_add_u32 s68, s68, 4096
  s_waitcnt vmcnt(11) lgkmcnt(6)
  v_mfma_f32_32x32x16_bf16 v[160:175], v[64:67], v[48:51], v[160:175]
  ds_read_b128 v[88:91], v2 offset:19136
  s_waitcnt lgkmcnt(6)
  v_mfma_f32_32x32x16_bf16 v[176:191], v[68:71], v[48:51], v[176:191]
  ds_read_b128 v[92:95], v2 offset:56128
  buffer_load_dwordx4 v[48:51], v4, s[32:35], s68 offen offset:0 sc1
  s_waitcnt vmcnt(11) lgkmcnt(6)
  v_mfma_f32_32x32x16_bf16 v[192:207], v[72:75], v[52:55], v[192:207]
  s_waitcnt lgkmcnt(3)
  v_cmp_le_u32 vcc, s12, v125
  s_cmp_eq_u64 vcc, -1
  s_cbranch_scc1 L_pok_7
L_psp_8:
  ds_read_b32 v125, v122 offset:0
  s_waitcnt lgkmcnt(0)
  v_cmp_le_u32 vcc, s12, v125
  s_cmp_eq_u64 vcc, -1
  s_cbranch_scc0 L_psp_8
L_pok_7:
  s_add_u32 s12, s12, 1
  ds_read_b128 v[64:67], v2 offset:9376
  v_mfma_f32_32x32x16_bf16 v[208:223], v[76:79], v[52:55], v[208:223]
  ds_read_b128 v[68:71], v2 offset:46368
  buffer_load_dwordx4 v[52:55], v4, s[32:35], s68 offen offset:1024 sc1
  s_waitcnt vmcnt(11)
  v_mfma_f32_32x32x16_bf16 v[192:207], v[80:83], v[56:59], v[192:207]
  ds_read_b128 v[72:75], v2 offset:9648
  s_waitcnt lgkmcnt(5)
  v_mfma_f32_32x32x16_bf16 v[208:223], v[84:87], v[56:59], v[208:223]
  ds_read_b128 v[76:79], v2 offset:46640
  buffer_load_dwordx4 v[56:59], v4, s[32:35], s68 offen offset:2048 sc1
  s_waitcnt vmcnt(11) lgkmcnt(5)
  v_mfma_f32_32x32x16_bf16 v[192:207], v[88:91], v[60:63], v[192:207]
  ds_read_b128 v[80:83], v2 offset:9920
  s_waitcnt lgkmcnt(5)
  v_mfma_f32_32x32x16_bf16 v[208:223], v[92:95], v[60:63], v[208:223]
  ds_read_b128 v[84:87], v2 offset:46912
  buffer_load_dwordx4 v[60:63], v4, s[32:35], s68 offen offset:3072 sc1
  s_add_u32 s68, s68, 4096
  s_waitcnt vmcnt(11) lgkmcnt(5)
  v_mfma_f32_32x32x16_bf16 v[160:175], v[64:67], v[16:19], v[160:175]
  ds_read_b128 v[88:91], v2 offset:18624
  s_waitcnt lgkmcnt(5)
  v_mfma_f32_32x32x16_bf16 v[176:191], v[68:71], v[16:19], v[176:191]
  ds_read_b128 v[92:95], v2 offset:55616
  buffer_load_dwordx4 v[16:19], v4, s[32:35], s68 offen offset:0 sc1
  s_waitcnt vmcnt(11) lgkmcnt(5)
  v_mfma_f32_32x32x16_bf16 v[160:175], v[72:75], v[20:23], v[160:175]
  ds_read_b128 v[64:67], v2 offset:18896
  s_waitcnt lgkmcnt(5)
  v_mfma_f32_32x32x16_bf16 v[176:191], v[76:79], v[20:23], v[176:191]
  ds_read_b128 v[68:71], v2 offset:55888
  buffer_load_dwordx4 v[20:23], v4, s[32:35], s68 offen offset:1024 sc1
  s_waitcnt vmcnt(11) lgkmcnt(5)
  v_mfma_f32_32x32x16_bf16 v[160:175], v[80:83], v[24:27], v[160:175]
  ds_read_b128 v[72:75], v2 offset:19168
  s_waitcnt lgkmcnt(5)
  v_mfma_f32_32x32x16_bf16 v[176:191], v[84:87], v[24:27], v[176:191]
  ds_read_b128 v[76:79], v2 offset:56160
  buffer_load_dwordx4 v[24:27], v4, s[32:35], s68 offen offset:2048 sc1
  s_waitcnt vmcnt(11) lgkmcnt(5)
  v_mfma_f32_32x32x16_bf16 v[192:207], v[88:91], v[28:31], v[192:207]
  ds_read_b128 v[80:83], v2 offset:9408
  s_waitcnt lgkmcnt(5)
  v_mfma_f32_32x32x16_bf16 v[208:223], v[92:95], v[28:31], v[208:223]
  ds_read_b128 v[84:87], v2 offset:46400
  buffer_load_dwordx4 v[28:31], v4, s[32:35], s68 offen offset:3072 sc1
  s_add_u32 s68, s68, 4096
  s_waitcnt vmcnt(11) lgkmcnt(5)
  v_mfma_f32_32x32x16_bf16 v[192:207], v[64:67], v[32:35], v[192:207]
  ds_read_b128 v[88:91], v2 offset:9680
  s_waitcnt lgkmcnt(5)
  v_mfma_f32_32x32x16_bf16 v[208:223], v[68:71], v[32:35], v[208:223]
  ds_read_b128 v[92:95], v2 offset:46672
  buffer_load_dwordx4 v[32:35], v4, s[32:35], s68 offen offset:0 sc1
  s_waitcnt vmcnt(11) lgkmcnt(5)
  v_mfma_f32_32x32x16_bf16 v[192:207], v[72:75], v[36:39], v[192:207]
  ds_read_b128 v[64:67], v2 offset:9952
  s_waitcnt lgkmcnt(5)
  v_mfma_f32_32x32x16_bf16 v[208:223], v[76:79], v[36:39], v[208:223]
  ds_read_b128 v[68:71], v2 offset:46944
  buffer_load_dwordx4 v[36:39], v4, s[32:35], s68 offen offset:1024 sc1
  s_waitcnt vmcnt(11) lgkmcnt(5)
  v_mfma_f32_32x32x16_bf16 v[160:175], v[80:83], v[40:43], v[160:175]
  ds_read_b128 v[72:75], v2 offset:18656
  buffer_load_dwordx2 v[106:107], v15, s[32:35], s5 offen offset:0 sc1
  buffer_load_dwordx2 v[108:109], v15, s[32:35], s5 offen offset:1024 sc1
  buffer_load_dwordx2 v[110:111], v15, s[32:35], s5 offen offset:2048 sc1
  buffer_load_dwordx2 v[112:113], v15, s[32:35], s5 offen offset:3072 sc1
  s_waitcnt lgkmcnt(5)
  v_mfma_f32_32x32x16_bf16 v[176:191], v[84:87], v[40:43], v[176:191]
  ds_read_b128 v[76:79], v2 offset:55648
  buffer_load_dwordx4 v[40:43], v4, s[32:35], s68 offen offset:2048 sc1
  s_waitcnt vmcnt(15) lgkmcnt(5)
  v_mfma_f32_32x32x16_bf16 v[160:175], v[88:91], v[44:47], v[160:175]
  ds_read_b128 v[80:83], v2 offset:18928
  s_waitcnt lgkmcnt(5)
  v_mfma_f32_32x32x16_bf16 v[176:191], v[92:95], v[44:47], v[176:191]
  ds_read_b32 v125, v122
  ds_read_b128 v[84:87], v2 offset:55920
  buffer_load_dwordx4 v[44:47], v4, s[32:35], s68 offen offset:3072 sc1
  s_add_u32 s68, s68, 4096
  s_waitcnt vmcnt(15) lgkmcnt(6)
  v_mfma_f32_32x32x16_bf16 v[160:175], v[64:67], v[48:51], v[160:175]
  ds_read_b128 v[88:91], v2 offset:19200
  s_waitcnt lgkmcnt(6)
  v_mfma_f32_32x32x16_bf16 v[176:191], v[68:71], v[48:51], v[176:191]
  ds_read_b128 v[92:95], v2 offset:56192
  buffer_load_dwordx4 v[48:51], v4, s[32:35], s68 offen offset:0 sc1
  s_waitcnt vmcnt(15) lgkmcnt(6)
  v_mfma_f32_32x32x16_bf16 v[192:207], v[72:75], v[52:55], v[192:207]
  s_waitcnt lgkmcnt(3)
  v_cmp_le_u32 vcc, s12, v125
  s_cmp_eq_u64 vcc, -1
  s_cbranch_scc1 L_pok_9
L_psp_10:
  ds_read_b32 v125, v122 offset:0
  s_waitcnt lgkmcnt(0)
  v_cmp_le_u32 vcc, s12, v125
  s_cmp_eq_u64 vcc, -1
  s_cbranch_scc0 L_psp_10
L_pok_9:
  s_add_u32 s12, s12, 1
  ds_read_b128 v[64:67], v2 offset:9440
  v_mfma_f32_32x32x16_bf16 v[208:223], v[76:79], v[52:55], v[208:223]
  ds_read_b128 v[68:71], v2 offset:46432
  buffer_load_dwordx4 v[52:55], v4, s[32:35], s68 offen offset:1024 sc1
  s_waitcnt vmcnt(15)
  v_mfma_f32_32x32x16_bf16 v[192:207], v[80:83], v[56:59], v[192:207]
  ds_read_b128 v[72:75], v2 offset:9712
  s_waitcnt lgkmcnt(5)
  v_mfma_f32_32x32x16_bf16 v[208:223], v[84:87], v[56:59], v[208:223]
  ds_read_b128 v[76:79], v2 offset:46704
  buffer_load_dwordx4 v[56:59], v4, s[32:35], s68 offen offset:2048 sc1
  s_waitcnt vmcnt(15) lgkmcnt(5)
  v_mfma_f32_32x32x16_bf16 v[192:207], v[88:91], v[60:63], v[192:207]
  ds_read_b128 v[80:83], v2 offset:9984
  s_waitcnt lgkmcnt(5)
  v_mfma_f32_32x32x16_bf16 v[208:223], v[92:95], v[60:63], v[208:223]
  ds_read_b128 v[84:87], v2 offset:46976
  buffer_load_dwordx4 v[60:63], v4, s[32:35], s68 offen offset:3072 sc1
  s_add_u32 s68, s68, 4096
  s_waitcnt vmcnt(15) lgkmcnt(5)
  v_mfma_f32_32x32x16_bf16 v[160:175], v[64:67], v[16:19], v[160:175]
  ds_read_b128 v[88:91], v2 offset:18688
  s_waitcnt lgkmcnt(5)
  v_mfma_f32_32x32x16_bf16 v[176:191], v[68:71], v[16:19], v[176:191]
  ds_read_b128 v[92:95], v2 offset:55680
  buffer_load_dwordx4 v[16:19], v4, s[32:35], s68 offen offset:0 sc1
  s_waitcnt vmcnt(15) lgkmcnt(5)
  v_mfma_f32_32x32x16_bf16 v[160:175], v[72:75], v[20:23], v[160:175]
  ds_read_b128 v[64:67], v2 offset:18960
  s_waitcnt lgkmcnt(5)
  v_mfma_f32_32x32x16_bf16 v[176:191], v[76:79], v[20:23], v[176:191]
  ds_read_b128 v[68:71], v2 offset:55952
  buffer_load_dwordx4 v[20:23], v4, s[32:35], s68 offen offset:1024 sc1
  s_waitcnt vmcnt(15) lgkmcnt(5)
  v_mfma_f32_32x32x16_bf16 v[160:175], v[80:83], v[24:27], v[160:175]
  ds_read_b128 v[72:75], v2 offset:19232
  s_waitcnt lgkmcnt(5)
  v_mfma_f32_32x32x16_bf16 v[176:191], v[84:87], v[24:27], v[176:191]
  ds_read_b128 v[76:79], v2 offset:56224
  buffer_load_dwordx4 v[24:27], v4, s[32:35], s68 offen offset:2048 sc1
  s_waitcnt vmcnt(15) lgkmcnt(5)
  v_mfma_f32_32x32x16_bf16 v[192:207], v[88:91], v[28:31], v[192:207]
  ds_read_b128 v[80:83], v2 offset:9472
  s_waitcnt lgkmcnt(5)
  v_mfma_f32_32x32x16_bf16 v[208:223], v[92:95], v[28:31], v[208:223]
  ds_read_b128 v[84:87], v2 offset:46464
  buffer_load_dwordx4 v[28:31], v4, s[32:35], s68 offen offset:3072 sc1
  s_add_u32 s68, s68, 4096
  s_waitcnt vmcnt(15) lgkmcnt(5)
  v_mfma_f32_32x32x16_bf16 v[192:207], v[64:67], v[32:35], v[192:207]
  ds_read_b128 v[88:91], v2 offset:9744
  s_waitcnt lgkmcnt(5)
  v_mfma_f32_32x32x16_bf16 v[208:223], v[68:71], v[32:35], v[208:223]
  ds_read_b128 v[92:95], v2 offset:46736
  buffer_load_dwordx4 v[32:35], v4, s[32:35], s68 offen offset:0 sc1
  s_waitcnt vmcnt(15) lgkmcnt(5)
  v_mfma_f32_32x32x16_bf16 v[192:207], v[72:75], v[36:39], v[192:207]
  ds_read_b128 v[64:67], v2 offset:10016
  s_waitcnt lgkmcnt(5)
  v_mfma_f32_32x32x16_bf16 v[208:223], v[76:79], v[36:39], v[208:223]
  ds_read_b128 v[68:71], v2 offset:47008
  buffer_load_dwordx4 v[36:39], v4, s[32:35], s68 offen offset:1024 sc1
  s_waitcnt vmcnt(11) lgkmcnt(5)
  v_mfma_f32_32x32x16_bf16 v[160:175], v[80:83], v[40:43], v[160:175]
  ds_read_b128 v[72:75], v2 offset:18720
  s_waitcnt lgkmcnt(5)
  v_mfma_f32_32x32x16_bf16 v[176:191], v[84:87], v[40:43], v[176:191]
  ds_read_b128 v[76:79], v2 offset:55712
  buffer_load_dwordx4 v[40:43], v4, s[32:35], s68 offen offset:2048 sc1
  s_waitcnt vmcnt(11) lgkmcnt(5)
  v_mfma_f32_32x32x16_bf16 v[160:175], v[88:91], v[44:47], v[160:175]
  ds_read_b128 v[80:83], v2 offset:18992
  s_mov_b32 s69, 0
  s_cmp_eq_u32 s25, 0
  s_cbranch_scc0 L_eok
L_echk:
  v_cmp_eq_u32 vcc, s46, v107
  v_cmp_eq_u32 s[80:81], s46, v109
  s_and_b64 vcc, vcc, s[80:81]
  v_cmp_eq_u32 s[80:81], s46, v111
  s_and_b64 vcc, vcc, s[80:81]
  v_cmp_eq_u32 s[80:81], s46, v113
  s_and_b64 vcc, vcc, s[80:81]
  s_cmp_eq_u64 vcc, -1
  s_cbranch_scc1 L_eok
  s_add_u32 s69, s69, 1
  s_cmp_ge_u32 s69, 40000
  s_cbranch_scc1 L_eok
  buffer_load_dwordx2 v[106:107], v15, s[32:35], s5 offen offset:0 sc1
  buffer_load_dwordx2 v[108:109], v15, s[32:35], s5 offen offset:1024 sc1
  buffer_load_dwordx2 v[110:111], v15, s[32:35], s5 offen offset:2048 sc1
  buffer_load_dwordx2 v[112:113], v15, s[32:35], s5 offen offset:3072 sc1
  s_waitcnt vmcnt(0)
  s_branch L_echk
L_eok:
  s_waitcnt lgkmcnt(5)
  v_mfma_f32_32x32x16_bf16 v[176:191], v[92:95], v[44:47], v[176:191]
  ds_read_b32 v125, v122
  ds_read_b128 v[84:87], v2 offset:55984
  buffer_load_dwordx4 v[44:47], v4, s[32:35], s68 offen offset:3072 sc1
  s_add_u32 s68, s68, 4096
  v_add_f32 v106, v106, v108
  v_add_f32 v110, v110, v112
  v_mov_b64 v[108:109], 0
  v_add_f32 v106, v106, v110
  s_waitcnt vmcnt(11) lgkmcnt(6)
  v_mfma_f32_32x32x16_bf16 v[160:175], v[64:67], v[48:51], v[160:175]
  ds_read_b128 v[88:91], v2 offset:19264
  v_and_b32 v107, s56, v106
  v_mov_b32 v110, s55
  v_sub_f32 v106, v106, v107
  v_mov_b32 v111, s55
  s_waitcnt lgkmcnt(6)
  v_mfma_f32_32x32x16_bf16 v[176:191], v[68:71], v[48:51], v[176:191]
  ds_read_b128 v[92:95], v2 offset:56256
  buffer_load_dwordx4 v[48:51], v4, s[32:35], s68 offen offset:0 sc1
  v_cvt_pk_bf16_f32 v106, v106, v107
  v_mov_b32 v107, 0
  v_mov_b32 v112, s55
  v_mov_b32 v113, s55
  s_waitcnt vmcnt(11) lgkmcnt(6)
  v_mfma_f32_32x32x16_bf16 v[192:207], v[72:75], v[52:55], v[192:207]
  s_waitcnt lgkmcnt(3)
  v_cmp_le_u32 vcc, s12, v125
  s_cmp_eq_u64 vcc, -1
  s_cbranch_scc1 L_pok_11
L_psp_12:
  ds_read_b32 v125, v122 offset:0
  s_waitcnt lgkmcnt(0)
  v_cmp_le_u32 vcc, s12, v125
  s_cmp_eq_u64 vcc, -1
  s_cbranch_scc0 L_psp_12
L_pok_11:
  s_add_u32 s12, s12, 1
  ds_read_b128 v[64:67], v2 offset:0
  v_mfma_f32_32x32x16_bf16 v[208:223], v[76:79], v[52:55], v[208:223]
  ds_read_b128 v[68:71], v2 offset:36992
  buffer_load_dwordx4 v[52:55], v4, s[32:35], s68 offen offset:1024 sc1
  v_mfma_f32_32x32x16_bf16 v[160:175], v[110:113], v[106:109], v[160:175]
  v_mfma_f32_32x32x16_bf16 v[176:191], v[110:113], v[106:109], v[176:191]
  s_waitcnt vmcnt(11)
  v_mfma_f32_32x32x16_bf16 v[192:207], v[80:83], v[56:59], v[192:207]
  ds_read_b128 v[72:75], v2 offset:272
  s_waitcnt lgkmcnt(5)
  v_mfma_f32_32x32x16_bf16 v[208:223], v[84:87], v[56:59], v[208:223]
  ds_read_b128 v[76:79], v2 offset:37264
  buffer_load_dwordx4 v[56:59], v4, s[32:35], s68 offen offset:2048 sc1
  s_waitcnt vmcnt(11) lgkmcnt(5)
  v_mfma_f32_32x32x16_bf16 v[192:207], v[88:91], v[60:63], v[192:207]
  ds_read_b128 v[80:83], v2 offset:544
  s_waitcnt lgkmcnt(5)
  v_mfma_f32_32x32x16_bf16 v[208:223], v[92:95], v[60:63], v[208:223]
  ds_read_b128 v[84:87], v2 offset:37536
  buffer_load_dwordx4 v[60:63], v4, s[32:35], s68 offen offset:3072 sc1
  s_add_u32 s68, s68, 4096
  s_waitcnt vmcnt(11) lgkmcnt(5)
  v_mfma_f32_32x32x16_bf16 v[128:143], v[64:67], v[16:19], v[128:143]
  ds_read_b128 v[88:91], v2 offset:32
  s_waitcnt lgkmcnt(5)
  v_mfma_f32_32x32x16_bf16 v[144:159], v[68:71], v[16:19], v[144:159]
  ds_read_b128 v[92:95], v2 offset:37024
  buffer_load_dwordx4 v[16:19], v4, s[32:35], s68 offen offset:0 sc1
  s_waitcnt vmcnt(11) lgkmcnt(5)
  v_mfma_f32_32x32x16_bf16 v[128:143], v[72:75], v[20:23], v[128:143]
  ds_read_b128 v[64:67], v2 offset:304
  s_waitcnt lgkmcnt(5)
  v_mfma_f32_32x32x16_bf16 v[144:159], v[76:79], v[20:23], v[144:159]
  ds_read_b128 v[68:71], v2 offset:37296
  buffer_load_dwordx4 v[20:23], v4, s[32:35], s68 offen offset:1024 sc1
  s_waitcnt vmcnt(11) lgkmcnt(5)
  v_mfma_f32_32x32x16_bf16 v[128:143], v[80:83], v[24:27], v[128:143]
  ds_read_b128 v[72:75], v2 offset:576
  v_add_f32 v160, v160, v192
  v_add_f32 v161, v161, v193
  s_waitcnt lgkmcnt(5)
  v_mfma_f32_32x32x16_bf16 v[144:159], v[84:87], v[24:27], v[144:159]
  ds_read_b128 v[76:79], v2 offset:37568
  buffer_load_dwordx4 v[24:27], v4, s[32:35], s68 offen offset:2048 sc1
  v_add_f32 v162, v162, v194
  v_add_f32 v163, v163, v195
  s_waitcnt vmcnt(11) lgkmcnt(5)
  v_mfma_f32_32x32x16_bf16 v[128:143], v[88:91], v[28:31], v[128:143]
  ds_read_b128 v[80:83], v2 offset:64
  v_fma_f32 v192, v192, -2.0, v160
  v_fma_f32 v193, v193, -2.0, v161
  s_waitcnt lgkmcnt(5)
  v_mfma_f32_32x32x16_bf16 v[144:159], v[92:95], v[28:31], v[144:159]
  ds_read_b128 v[84:87], v2 offset:37056
  buffer_load_dwordx4 v[28:31], v4, s[32:35], s68 offen offset:3072 sc1
  s_add_u32 s68, s68, 4096
  v_fma_f32 v194, v194, -2.0, v162
  v_fma_f32 v195, v195, -2.0, v163
  s_waitcnt vmcnt(11) lgkmcnt(5)
  v_mfma_f32_32x32x16_bf16 v[128:143], v[64:67], v[32:35], v[128:143]
  ds_read_b128 v[88:91], v2 offset:336
  v_add_f32 v164, v164, v196
  v_add_f32 v165, v165, v197
  s_waitcnt lgkmcnt(5)
  v_mfma_f32_32x32x16_bf16 v[144:159], v[68:71], v[32:35], v[144:159]
  ds_read_b128 v[92:95], v2 offset:37328
  buffer_load_dwordx4 v[32:35], v4, s[32:35], s68 offen offset:0 sc1
  v_add_f32 v166, v166, v198
  v_add_f32 v167, v167, v199
  s_waitcnt vmcnt(11) lgkmcnt(5)
  v_mfma_f32_32x32x16_bf16 v[128:143], v[72:75], v[36:39], v[128:143]
  ds_read_b128 v[64:67], v2 offset:608
  v_fma_f32 v196, v196, -2.0, v164
  v_fma_f32 v197, v197, -2.0, v165
  s_waitcnt lgkmcnt(5)
  v_mfma_f32_32x32x16_bf16 v[144:159], v[76:79], v[36:39], v[144:159]
  ds_read_b128 v[68:71], v2 offset:37600
  buffer_load_dwordx4 v[36:39], v4, s[32:35], s68 offen offset:1024 sc1
  v_fma_f32 v198, v198, -2.0, v166
  v_fma_f32 v199, v199, -2.0, v167
  s_waitcnt vmcnt(11) lgkmcnt(5)
  v_mfma_f32_32x32x16_bf16 v[128:143], v[80:83], v[40:43], v[128:143]
  ds_read_b128 v[72:75], v2 offset:96
  v_add_f32 v168, v168, v200
  v_add_f32 v169, v169, v201
  s_waitcnt lgkmcnt(5)
  v_mfma_f32_32x32x16_bf16 v[144:159], v[84:87], v[40:43], v[144:159]
  ds_read_b128 v[76:79], v2 offset:37088
  buffer_load_dwordx4 v[40:43], v4, s[32:35], s68 offen offset:2048 sc1
  v_add_f32 v170, v170, v202
  v_add_f32 v171, v171, v203
  s_waitcnt vmcnt(11) lgkmcnt(5)
  v_mfma_f32_32x32x16_bf16 v[128:143], v[88:91], v[44:47], v[128:143]
  ds_read_b128 v[80:83], v2 offset:368
  v_fma_f32 v200, v200, -2.0, v168
  v_fma_f32 v201, v201, -2.0, v169
  s_waitcnt lgkmcnt(5)
  v_mfma_f32_32x32x16_bf16 v[144:159], v[92:95], v[44:47], v[144:159]
  ds_read_b32 v125, v122
  ds_read_b128 v[84:87], v2 offset:37360
  buffer_load_dwordx4 v[44:47], v4, s[32:35], s68 offen offset:3072 sc1
  s_add_u32 s68, s68, 4096
  v_fma_f32 v202, v202, -2.0, v170
  v_fma_f32 v203, v203, -2.0, v171
  s_waitcnt vmcnt(11) lgkmcnt(6)
  v_mfma_f32_32x32x16_bf16 v[128:143], v[64:67], v[48:51], v[128:143]
  ds_read_b128 v[88:91], v2 offset:640
  v_add_f32 v172, v172, v204
  v_add_f32 v173, v173, v205
  s_waitcnt lgkmcnt(6)
  v_mfma_f32_32x32x16_bf16 v[144:159], v[68:71], v[48:51], v[144:159]
  ds_read_b128 v[92:95], v2 offset:37632
  buffer_load_dwordx4 v[48:51], v4, s[32:35], s68 offen offset:0 sc1
  v_add_f32 v174, v174, v206
  v_add_f32 v175, v175, v207
  s_waitcnt vmcnt(11) lgkmcnt(6)
  v_mfma_f32_32x32x16_bf16 v[128:143], v[72:75], v[52:55], v[128:143]
  s_waitcnt lgkmcnt(3)
  v_cmp_le_u32 vcc, s12, v125
  s_cmp_eq_u64 vcc, -1
  s_cbranch_scc1 L_pok_13
L_psp_14:
  ds_read_b32 v125, v122 offset:0
  s_waitcnt lgkmcnt(0)
  v_cmp_le_u32 vcc, s12, v125
  s_cmp_eq_u64 vcc, -1
  s_cbranch_scc0 L_psp_14
L_pok_13:
  s_add_u32 s12, s12, 1
  ds_read_b128 v[64:67], v2 offset:128
  v_fma_f32 v204, v204, -2.0, v172
  v_fma_f32 v205, v205, -2.0, v173
  v_mfma_f32_32x32x16_bf16 v[144:159], v[76:79], v[52:55], v[144:159]
  ds_read_b128 v[68:71], v2 offset:37120
  buffer_load_dwordx4 v[52:55], v4, s[32:35], s68 offen offset:1024 sc1
  v_fma_f32 v206, v206, -2.0, v174
  v_fma_f32 v207, v207, -2.0, v175
  s_waitcnt vmcnt(11)
  v_mfma_f32_32x32x16_bf16 v[128:143], v[80:83], v[56:59], v[128:143]
  ds_read_b128 v[72:75], v2 offset:400
  v_add_f32 v224, v224, v192
  v_add_f32 v176, v176, v208
  v_add_f32 v177, v177, v209
  s_waitcnt lgkmcnt(5)
  v_mfma_f32_32x32x16_bf16 v[144:159], v[84:87], v[56:59], v[144:159]
  ds_read_b128 v[76:79], v2 offset:37392
  buffer_load_dwordx4 v[56:59], v4, s[32:35], s68 offen offset:2048 sc1
  v_add_f32 v225, v225, v193
  v_add_f32 v178, v178, v210
  v_add_f32 v179, v179, v211
  s_waitcnt vmcnt(11) lgkmcnt(5)
  v_mfma_f32_32x32x16_bf16 v[128:143], v[88:91], v[60:63], v[128:143]
  ds_read_b128 v[80:83], v2 offset:672
  v_add_f32 v226, v226, v194
  v_fma_f32 v208, v208, -2.0, v176
  v_fma_f32 v209, v209, -2.0, v177
  s_waitcnt lgkmcnt(5)
  v_mfma_f32_32x32x16_bf16 v[144:159], v[92:95], v[60:63], v[144:159]
  ds_read_b128 v[84:87], v2 offset:37664
  buffer_load_dwordx4 v[60:63], v4, s[32:35], s68 offen offset:3072 sc1
  s_add_u32 s68, s68, 4096
  v_add_f32 v227, v227, v195
  v_fma_f32 v210, v210, -2.0, v178
  v_fma_f32 v211, v211, -2.0, v179
  s_waitcnt vmcnt(11) lgkmcnt(5)
  v_mfma_f32_32x32x16_bf16 v[128:143], v[64:67], v[16:19], v[128:143]
  ds_read_b128 v[88:91], v2 offset:160
  v_add_f32 v228, v228, v196
  v_add_f32 v180, v180, v212
  v_add_f32 v181, v181, v213
  s_waitcnt lgkmcnt(5)
  v_mfma_f32_32x32x16_bf16 v[144:159], v[68:71], v[16:19], v[144:159]
  ds_read_b128 v[92:95], v2 offset:37152
  buffer_load_dwordx4 v[16:19], v4, s[32:35], s68 offen offset:0 sc1
  v_add_f32 v229, v229, v197
  v_add_f32 v182, v182, v214
  v_add_f32 v183, v183, v215
  s_waitcnt vmcnt(11) lgkmcnt(5)
  v_mfma_f32_32x32x16_bf16 v[128:143], v[72:75], v[20:23], v[128:143]
  ds_read_b128 v[64:67], v2 offset:432
  v_add_f32 v230, v230, v198
  v_fma_f32 v212, v212, -2.0, v180
  v_fma_f32 v213, v213, -2.0, v181
  s_waitcnt lgkmcnt(5)
  v_mfma_f32_32x32x16_bf16 v[144:159], v[76:79], v[20:23], v[144:159]
  ds_read_b128 v[68:71], v2 offset:37424
  buffer_load_dwordx4 v[20:23], v4, s[32:35], s68 offen offset:1024 sc1
  v_add_f32 v231, v231, v199
  v_fma_f32 v214, v214, -2.0, v182
  v_fma_f32 v215, v215, -2.0, v183
  s_waitcnt vmcnt(11) lgkmcnt(5)
  v_mfma_f32_32x32x16_bf16 v[128:143], v[80:83], v[24:27], v[128:143]
  ds_read_b128 v[72:75], v2 offset:704
  v_add_f32 v232, v232, v200
  v_add_f32 v184, v184, v216
  v_add_f32 v185, v185, v217
  s_waitcnt lgkmcnt(5)
  v_mfma_f32_32x32x16_bf16 v[144:159], v[84:87], v[24:27], v[144:159]
  ds_read_b128 v[76:79], v2 offset:37696
  buffer_load_dwordx4 v[24:27], v4, s[32:35], s68 offen offset:2048 sc1
  v_add_f32 v233, v233, v201
  v_add_f32 v186, v186, v218
  v_add_f32 v187, v187, v219
  s_waitcnt vmcnt(11) lgkmcnt(5)
  v_mfma_f32_32x32x16_bf16 v[128:143], v[88:91], v[28:31], v[128:143]
  ds_read_b128 v[80:83], v2 offset:192
  v_add_f32 v234, v234, v202
  v_fma_f32 v216, v216, -2.0, v184
  v_fma_f32 v217, v217, -2.0, v185
  s_waitcnt lgkmcnt(5)
  v_mfma_f32_32x32x16_bf16 v[144:159], v[92:95], v[28:31], v[144:159]
  ds_read_b128 v[84:87], v2 offset:37184
  buffer_load_dwordx4 v[28:31], v4, s[32:35], s68 offen offset:3072 sc1
  s_add_u32 s68, s68, 4096
  v_add_f32 v235, v235, v203
  v_fma_f32 v218, v218, -2.0, v186
  v_fma_f32 v219, v219, -2.0, v187
  s_waitcnt vmcnt(11) lgkmcnt(5)
  v_mfma_f32_32x32x16_bf16 v[128:143], v[64:67], v[32:35], v[128:143]
  ds_read_b128 v[88:91], v2 offset:464
  v_add_f32 v236, v236, v204
  v_add_f32 v188, v188, v220
  v_add_f32 v189, v189, v221
  s_waitcnt lgkmcnt(5)
  v_mfma_f32_32x32x16_bf16 v[144:159], v[68:71], v[32:35], v[144:159]
  ds_read_b128 v[92:95], v2 offset:37456
  buffer_load_dwordx4 v[32:35], v4, s[32:35], s68 offen offset:0 sc1
  v_add_f32 v237, v237, v205
  v_add_f32 v190, v190, v222
  v_add_f32 v191, v191, v223
  s_waitcnt vmcnt(11) lgkmcnt(5)
  v_mfma_f32_32x32x16_bf16 v[128:143], v[72:75], v[36:39], v[128:143]
  ds_read_b128 v[64:67], v2 offset:736
  v_add_f32 v238, v238, v206
  v_fma_f32 v220, v220, -2.0, v188
  v_fma_f32 v221, v221, -2.0, v189
  s_waitcnt lgkmcnt(5)
  v_mfma_f32_32x32x16_bf16 v[144:159], v[76:79], v[36:39], v[144:159]
  ds_read_b128 v[68:71], v2 offset:37728
  buffer_load_dwordx4 v[36:39], v4, s[32:35], s68 offen offset:1024 sc1
  v_add_f32 v239, v239, v207
  v_fma_f32 v222, v222, -2.0, v190
  v_fma_f32 v223, v223, -2.0, v191
  s_waitcnt vmcnt(11) lgkmcnt(5)
  v_mfma_f32_32x32x16_bf16 v[128:143], v[80:83], v[40:43], v[128:143]
  ds_read_b128 v[72:75], v2 offset:224
  v_add_f32 v240, v240, v208
  v_add_f32 v241, v241, v209
  s_waitcnt lgkmcnt(5)
  v_mfma_f32_32x32x16_bf16 v[144:159], v[84:87], v[40:43], v[144:159]
  ds_read_b128 v[76:79], v2 offset:37216
  buffer_load_dwordx4 v[40:43], v4, s[32:35], s68 offen offset:2048 sc1
  v_add_f32 v242, v242, v210
  v_add_f32 v243, v243, v211
  s_waitcnt vmcnt(11) lgkmcnt(5)
  v_mfma_f32_32x32x16_bf16 v[128:143], v[88:91], v[44:47], v[128:143]
  ds_read_b128 v[80:83], v2 offset:496
  v_add_f32 v244, v244, v212
  v_add_f32 v245, v245, v213
  s_waitcnt lgkmcnt(5)
  v_mfma_f32_32x32x16_bf16 v[144:159], v[92:95], v[44:47], v[144:159]
  ds_read_b32 v125, v122
  ds_read_b128 v[84:87], v2 offset:37488
  buffer_load_dwordx4 v[44:47], v4, s[32:35], s68 offen offset:3072 sc1
  s_add_u32 s68, s68, 4096
  v_add_f32 v246, v246, v214
  v_add_f32 v247, v247, v215
  s_waitcnt vmcnt(11) lgkmcnt(6)
  v_mfma_f32_32x32x16_bf16 v[128:143], v[64:67], v[48:51], v[128:143]
  ds_read_b128 v[88:91], v2 offset:768
  v_add_f32 v248, v248, v216
  v_add_f32 v249, v249, v217
  s_waitcnt lgkmcnt(6)
  v_mfma_f32_32x32x16_bf16 v[144:159], v[68:71], v[48:51], v[144:159]
  ds_read_b128 v[92:95], v2 offset:37760
  buffer_load_dwordx4 v[48:51], v4, s[32:35], s68 offen offset:0 sc1
  v_add_f32 v250, v250, v218
  v_add_f32 v251, v251, v219
  s_waitcnt vmcnt(11) lgkmcnt(6)
  v_mfma_f32_32x32x16_bf16 v[128:143], v[72:75], v[52:55], v[128:143]
  s_waitcnt lgkmcnt(3)
  v_cmp_le_u32 vcc, s12, v125
  s_cmp_eq_u64 vcc, -1
  s_cbranch_scc1 L_pok_15
L_psp_16:
  ds_read_b32 v125, v122 offset:0
  s_waitcnt lgkmcnt(0)
  v_cmp_le_u32 vcc, s12, v125
  s_cmp_eq_u64 vcc, -1
  s_cbranch_scc0 L_psp_16
L_pok_15:
  s_add_u32 s12, s12, 1
  ds_read_b128 v[64:67], v2 offset:27744
  v_add_f32 v252, v252, v220
  v_add_f32 v253, v253, v221
  v_mfma_f32_32x32x16_bf16 v[144:159], v[76:79], v[52:55], v[144:159]
  ds_read_b128 v[68:71], v2 offset:64736
  buffer_load_dwordx4 v[52:55], v4, s[32:35], s68 offen offset:1024 sc1
  v_add_f32 v254, v254, v222
  v_add_f32 v255, v255, v223
  s_waitcnt vmcnt(11)
  v_mfma_f32_32x32x16_bf16 v[128:143], v[80:83], v[56:59], v[128:143]
  ds_read_b128 v[72:75], v2 offset:28016
  s_waitcnt lgkmcnt(5)
  v_mfma_f32_32x32x16_bf16 v[144:159], v[84:87], v[56:59], v[144:159]
  ds_read_b128 v[76:79], v2 offset:65008
  buffer_load_dwordx4 v[56:59], v4, s[32:35], s68 offen offset:2048 sc1
  s_waitcnt vmcnt(11) lgkmcnt(5)
  v_mfma_f32_32x32x16_bf16 v[128:143], v[88:91], v[60:63], v[128:143]
  ds_read_b128 v[80:83], v2 offset:28288
  s_waitcnt lgkmcnt(5)
  v_mfma_f32_32x32x16_bf16 v[144:159], v[92:95], v[60:63], v[144:159]
  ds_read_b128 v[84:87], v2 offset:65280
  buffer_load_dwordx4 v[60:63], v4, s[32:35], s68 offen offset:3072 sc1
  s_add_u32 s68, s68, 4096
  s_waitcnt vmcnt(11) lgkmcnt(5)
  v_mfma_f32_32x32x16_bf16 v[224:239], v[64:67], v[16:19], v[224:239]
  ds_read_b128 v[88:91], v2 offset:27776
  s_waitcnt lgkmcnt(5)
  v_mfma_f32_32x32x16_bf16 v[240:255], v[68:71], v[16:19], v[240:255]
  ds_read_b128 v[92:95], v2 offset:64768
  buffer_load_dwordx4 v[16:19], v4, s[32:35], s68 offen offset:0 sc1
  s_waitcnt vmcnt(11) lgkmcnt(5)
  v_mfma_f32_32x32x16_bf16 v[224:239], v[72:75], v[20:23], v[224:239]
  ds_read_b128 v[64:67], v2 offset:28048
  s_waitcnt lgkmcnt(5)
  v_mfma_f32_32x32x16_bf16 v[240:255], v[76:79], v[20:23], v[240:255]
  ds_read_b128 v[68:71], v2 offset:65040
  buffer_load_dwordx4 v[20:23], v4, s[32:35], s68 offen offset:1024 sc1
  v_add_f32 v128, v128, v160
  v_add_f32 v129, v129, v161
  v_add_f32 v130, v130, v162
  v_add_f32 v131, v131, v163
  s_waitcnt vmcnt(11) lgkmcnt(5)
  v_mfma_f32_32x32x16_bf16 v[224:239], v[80:83], v[24:27], v[224:239]
  ds_read_b128 v[72:75], v2 offset:28320
  v_add_f32 v132, v132, v164
  v_add_f32 v133, v133, v165
  v_add_f32 v134, v134, v166
  v_add_f32 v135, v135, v167
  s_waitcnt lgkmcnt(5)
  v_mfma_f32_32x32x16_bf16 v[240:255], v[84:87], v[24:27], v[240:255]
  ds_read_b128 v[76:79], v2 offset:65312
  buffer_load_dwordx4 v[24:27], v4, s[32:35], s68 offen offset:2048 sc1
  v_add_f32 v136, v136, v168
  v_add_f32 v137, v137, v169
  v_add_f32 v138, v138, v170
  v_add_f32 v139, v139, v171
  s_waitcnt vmcnt(11) lgkmcnt(5)
  v_mfma_f32_32x32x16_bf16 v[224:239], v[88:91], v[28:31], v[224:239]
  ds_read_b128 v[80:83], v2 offset:27808
  v_add_f32 v140, v140, v172
  v_add_f32 v141, v141, v173
  v_add_f32 v142, v142, v174
  v_add_f32 v143, v143, v175
  s_waitcnt lgkmcnt(5)
  v_mfma_f32_32x32x16_bf16 v[240:255], v[92:95], v[28:31], v[240:255]
  ds_read_b128 v[84:87], v2 offset:64800
  buffer_load_dwordx4 v[28:31], v4, s[32:35], s68 offen offset:3072 sc1
  s_add_u32 s68, s68, 4096
  v_cvt_pk_bf16_f32 v192, v128, v129
  v_cvt_pk_bf16_f32 v193, v130, v131
  v_cvt_pk_bf16_f32 v194, v132, v133
  v_cvt_pk_bf16_f32 v195, v134, v135
  s_waitcnt vmcnt(11) lgkmcnt(5)
  v_mfma_f32_32x32x16_bf16 v[224:239], v[64:67], v[32:35], v[224:239]
  ds_read_b128 v[88:91], v2 offset:28080
  v_cvt_pk_bf16_f32 v196, v136, v137
  v_cvt_pk_bf16_f32 v197, v138, v139
  v_cvt_pk_bf16_f32 v198, v140, v141
  v_cvt_pk_bf16_f32 v199, v142, v143
  s_waitcnt lgkmcnt(5)
  v_mfma_f32_32x32x16_bf16 v[240:255], v[68:71], v[32:35], v[240:255]
  ds_read_b128 v[92:95], v2 offset:65072
  buffer_load_dwordx4 v[32:35], v4, s[32:35], s68 offen offset:0 sc1
  v_add_f32 v144, v144, v176
  v_add_f32 v145, v145, v177
  v_add_f32 v146, v146, v178
  v_add_f32 v147, v147, v179
  ds_write_b128 v3, v[192:195] offset:0
  s_waitcnt vmcnt(11) lgkmcnt(6)
  v_mfma_f32_32x32x16_bf16 v[224:239], v[72:75], v[36:39], v[224:239]
  ds_read_b128 v[64:67], v2 offset:28352
  v_add_f32 v148, v148, v180
  v_add_f32 v149, v149, v181
  v_add_f32 v150, v150, v182
  v_add_f32 v151, v151, v183
  s_waitcnt lgkmcnt(6)
  v_mfma_f32_32x32x16_bf16 v[240:255], v[76:79], v[36:39], v[240:255]
  ds_read_b128 v[68:71], v2 offset:65344
  buffer_load_dwordx4 v[36:39], v4, s[32:35], s68 offen offset:1024 sc1
  v_add_f32 v152, v152, v184
  v_add_f32 v153, v153, v185
  v_add_f32 v154, v154, v186
  v_add_f32 v155, v155, v187
  ds_write_b128 v3, v[196:199] offset:16
  s_waitcnt vmcnt(11) lgkmcnt(7)
  v_mfma_f32_32x32x16_bf16 v[224:239], v[80:83], v[40:43], v[224:239]
  ds_read_b128 v[72:75], v2 offset:27840
  v_add_f32 v156, v156, v188
  v_add_f32 v157, v157, v189
  v_add_f32 v158, v158, v190
  v_add_f32 v159, v159, v191
  s_waitcnt lgkmcnt(7)
  v_mfma_f32_32x32x16_bf16 v[240:255], v[84:87], v[40:43], v[240:255]
  ds_read_b128 v[76:79], v2 offset:64832
  buffer_load_dwordx4 v[40:43], v4, s[32:35], s68 offen offset:2048 sc1
  v_cvt_pk_bf16_f32 v208, v144, v145
  v_cvt_pk_bf16_f32 v209, v146, v147
  v_cvt_pk_bf16_f32 v210, v148, v149
  v_cvt_pk_bf16_f32 v211, v150, v151
  s_waitcnt vmcnt(11) lgkmcnt(7)
  v_mfma_f32_32x32x16_bf16 v[224:239], v[88:91], v[44:47], v[224:239]
  ds_read_b128 v[80:83], v2 offset:28112
  v_cvt_pk_bf16_f32 v212, v152, v153
  v_cvt_pk_bf16_f32 v213, v154, v155
  v_cvt_pk_bf16_f32 v214, v156, v157
  v_cvt_pk_bf16_f32 v215, v158, v159
  s_waitcnt lgkmcnt(7)
  v_mfma_f32_32x32x16_bf16 v[240:255], v[92:95], v[44:47], v[240:255]
  ds_read_b32 v125, v122
  ds_read_b128 v[84:87], v2 offset:65104
  buffer_load_dwordx4 v[44:47], v4, s[32:35], s68 offen offset:3072 sc1
  s_add_u32 s68, s68, 4096
  ds_write_b128 v3, v[208:211] offset:20480
  s_waitcnt vmcnt(11) lgkmcnt(8)
  v_mfma_f32_32x32x16_bf16 v[224:239], v[64:67], v[48:51], v[224:239]
  ds_read_b128 v[88:91], v2 offset:28384
  ds_write_b128 v3, v[212:215] offset:20496
  s_waitcnt lgkmcnt(9)
  v_mfma_f32_32x32x16_bf16 v[240:255], v[68:71], v[48:51], v[240:255]
  ds_read_b128 v[92:95], v2 offset:65376
  buffer_load_dwordx4 v[48:51], v4, s[32:35], s68 offen offset:0 sc1
  s_mov_b64 exec, 1
  ds_write2_b32 v123, v124, v124 offset0:12 offset1:16
  s_mov_b64 exec, -1
  s_waitcnt vmcnt(11) lgkmcnt(9)
  v_mfma_f32_32x32x16_bf16 v[224:239], v[72:75], v[52:55], v[224:239]
  s_waitcnt lgkmcnt(6)
  v_cmp_le_u32 vcc, s12, v125
  s_cmp_eq_u64 vcc, -1
  s_cbranch_scc1 L_pok_17
L_psp_18:
  ds_read_b32 v125, v122 offset:0
  s_waitcnt lgkmcnt(0)
  v_cmp_le_u32 vcc, s12, v125
  s_cmp_eq_u64 vcc, -1
  s_cbranch_scc0 L_psp_18
L_pok_17:
  s_add_u32 s12, s12, 1
  ds_read_b128 v[64:67], v2 offset:27872
  v_mfma_f32_32x32x16_bf16 v[240:255], v[76:79], v[52:55], v[240:255]
  ds_read_b128 v[68:71], v2 offset:64864
  buffer_load_dwordx4 v[52:55], v4, s[32:35], s68 offen offset:1024 sc1
  v_mov_b64 v[106:107], 0
  v_mov_b64 v[108:109], 0
  s_waitcnt vmcnt(11)
  v_mfma_f32_32x32x16_bf16 v[224:239], v[80:83], v[56:59], v[224:239]
  ds_read_b128 v[72:75], v2 offset:28144
  s_waitcnt lgkmcnt(8)
  v_mfma_f32_32x32x16_bf16 v[240:255], v[84:87], v[56:59], v[240:255]
  ds_read_b128 v[76:79], v2 offset:65136
  buffer_load_dwordx4 v[56:59], v4, s[32:35], s68 offen offset:2048 sc1
  s_waitcnt vmcnt(11) lgkmcnt(7)
  v_mfma_f32_32x32x16_bf16 v[224:239], v[88:91], v[60:63], v[224:239]
  ds_read_b128 v[80:83], v2 offset:28416
  s_waitcnt lgkmcnt(6)
  v_mfma_f32_32x32x16_bf16 v[240:255], v[92:95], v[60:63], v[240:255]
  ds_read_b128 v[84:87], v2 offset:65408
  buffer_load_dwordx4 v[60:63], v4, s[32:35], s68 offen offset:3072 sc1
  s_add_u32 s68, s68, 4096
  s_waitcnt vmcnt(11) lgkmcnt(5)
  v_mfma_f32_32x32x16_bf16 v[224:239], v[64:67], v[16:19], v[224:239]
  ds_read_b128 v[88:91], v2 offset:27904
  s_waitcnt lgkmcnt(5)
  v_mfma_f32_32x32x16_bf16 v[240:255], v[68:71], v[16:19], v[240:255]
  ds_read_b128 v[92:95], v2 offset:64896
  s_waitcnt vmcnt(10) lgkmcnt(5)
  v_mfma_f32_32x32x16_bf16 v[224:239], v[72:75], v[20:23], v[224:239]
  ds_read_b128 v[64:67], v2 offset:28176
  s_waitcnt lgkmcnt(5)
  v_mfma_f32_32x32x16_bf16 v[240:255], v[76:79], v[20:23], v[240:255]
  ds_read_b128 v[68:71], v2 offset:65168
  s_waitcnt vmcnt(9) lgkmcnt(5)
  v_mfma_f32_32x32x16_bf16 v[224:239], v[80:83], v[24:27], v[224:239]
  ds_read_b128 v[72:75], v2 offset:28448
  s_waitcnt lgkmcnt(5)
  v_mfma_f32_32x32x16_bf16 v[240:255], v[84:87], v[24:27], v[240:255]
  ds_read_b128 v[76:79], v2 offset:65440
  s_waitcnt vmcnt(8) lgkmcnt(5)
  v_mfma_f32_32x32x16_bf16 v[224:239], v[88:91], v[28:31], v[224:239]
  ds_read_b128 v[80:83], v2 offset:27936
  s_waitcnt lgkmcnt(5)
  v_mfma_f32_32x32x16_bf16 v[240:255], v[92:95], v[28:31], v[240:255]
  ds_read_b128 v[84:87], v2 offset:64928
  s_waitcnt vmcnt(7) lgkmcnt(5)
  v_mfma_f32_32x32x16_bf16 v[224:239], v[64:67], v[32:35], v[224:239]
  ds_read_b128 v[88:91], v2 offset:28208
  s_waitcnt lgkmcnt(5)
  v_mfma_f32_32x32x16_bf16 v[240:255], v[68:71], v[32:35], v[240:255]
  ds_read_b128 v[92:95], v2 offset:65200
  s_waitcnt vmcnt(6) lgkmcnt(5)
  v_mfma_f32_32x32x16_bf16 v[224:239], v[72:75], v[36:39], v[224:239]
  ds_read_b128 v[64:67], v2 offset:28480
  s_waitcnt lgkmcnt(5)
  v_mfma_f32_32x32x16_bf16 v[240:255], v[76:79], v[36:39], v[240:255]
  ds_read_b128 v[68:71], v2 offset:65472
  s_waitcnt vmcnt(5) lgkmcnt(5)
  v_mfma_f32_32x32x16_bf16 v[224:239], v[80:83], v[40:43], v[224:239]
  ds_read_b128 v[72:75], v2 offset:27968
  s_waitcnt lgkmcnt(5)
  v_mfma_f32_32x32x16_bf16 v[240:255], v[84:87], v[40:43], v[240:255]
  ds_read_b128 v[76:79], v2 offset:64960
  s_waitcnt vmcnt(4) lgkmcnt(5)
  v_mfma_f32_32x32x16_bf16 v[224:239], v[88:91], v[44:47], v[224:239]
  ds_read_b128 v[80:83], v2 offset:28240
  s_waitcnt lgkmcnt(5)
  v_mfma_f32_32x32x16_bf16 v[240:255], v[92:95], v[44:47], v[240:255]
  ds_read_b128 v[84:87], v2 offset:65232
  s_waitcnt vmcnt(3) lgkmcnt(5)
  v_mfma_f32_32x32x16_bf16 v[224:239], v[64:67], v[48:51], v[224:239]
  ds_read_b128 v[88:91], v2 offset:28512
  s_waitcnt lgkmcnt(5)
  v_mfma_f32_32x32x16_bf16 v[240:255], v[68:71], v[48:51], v[240:255]
  ds_read_b128 v[92:95], v2 offset:65504
  s_waitcnt vmcnt(2) lgkmcnt(5)
  v_mfma_f32_32x32x16_bf16 v[224:239], v[72:75], v[52:55], v[224:239]
  s_waitcnt lgkmcnt(4)
  v_mfma_f32_32x32x16_bf16 v[240:255], v[76:79], v[52:55], v[240:255]
  s_waitcnt vmcnt(1) lgkmcnt(3)
  v_mfma_f32_32x32x16_bf16 v[224:239], v[80:83], v[56:59], v[224:239]
  s_waitcnt lgkmcnt(2)
  v_mfma_f32_32x32x16_bf16 v[240:255], v[84:87], v[56:59], v[240:255]
  s_waitcnt vmcnt(0) lgkmcnt(1)
  v_mfma_f32_32x32x16_bf16 v[224:239], v[88:91], v[60:63], v[224:239]
  s_waitcnt lgkmcnt(0)
  v_mfma_f32_32x32x16_bf16 v[240:255], v[92:95], v[60:63], v[240:255]
  s_cmp_eq_u32 s25, 1
  s_cbranch_scc1 L_mfinal
  v_dot2c_f32_bf16 v106, s55, v192
  v_dot2c_f32_bf16 v108, v192, v192
  v_dot2c_f32_bf16 v107, s55, v193
  v_dot2c_f32_bf16 v109, v193, v193
  v_dot2c_f32_bf16 v106, s55, v194
  v_dot2c_f32_bf16 v108, v194, v194
  v_dot2c_f32_bf16 v107, s55, v195
  v_dot2c_f32_bf16 v109, v195, v195
  v_dot2c_f32_bf16 v106, s55, v196
  v_dot2c_f32_bf16 v108, v196, v196
  v_dot2c_f32_bf16 v107, s55, v197
  v_dot2c_f32_bf16 v109, v197, v197
  v_dot2c_f32_bf16 v106, s55, v198
  v_dot2c_f32_bf16 v108, v198, v198
  v_dot2c_f32_bf16 v107, s55, v199
  v_dot2c_f32_bf16 v109, v199, v199
  v_cvt_pk_bf16_f32 v200, v224, v225
  v_cvt_pk_bf16_f32 v201, v226, v227
  v_cvt_pk_bf16_f32 v202, v228, v229
  v_cvt_pk_bf16_f32 v203, v230, v231
  v_cvt_pk_bf16_f32 v204, v232, v233
  v_cvt_pk_bf16_f32 v205, v234, v235
  v_cvt_pk_bf16_f32 v206, v236, v237
  v_cvt_pk_bf16_f32 v207, v238, v239
  v_cvt_pk_bf16_f32 v216, v240, v241
  v_cvt_pk_bf16_f32 v217, v242, v243
  v_cvt_pk_bf16_f32 v218, v244, v245
  v_cvt_pk_bf16_f32 v219, v246, v247
  v_cvt_pk_bf16_f32 v220, v248, v249
  v_cvt_pk_bf16_f32 v221, v250, v251
  v_cvt_pk_bf16_f32 v222, v252, v253
  v_cvt_pk_bf16_f32 v223, v254, v255
  v_dot2c_f32_bf16 v106, s55, v208
  v_dot2c_f32_bf16 v108, v208, v208
  v_dot2c_f32_bf16 v107, s55, v209
  v_dot2c_f32_bf16 v109, v209, v209
  v_dot2c_f32_bf16 v106, s55, v210
  v_dot2c_f32_bf16 v108, v210, v210
  v_dot2c_f32_bf16 v107, s55, v211
  v_dot2c_f32_bf16 v109, v211, v211
  v_dot2c_f32_bf16 v106, s55, v212
  v_dot2c_f32_bf16 v108, v212, v212
  v_dot2c_f32_bf16 v107, s55, v213
  v_dot2c_f32_bf16 v109, v213, v213
  v_dot2c_f32_bf16 v106, s55, v214
  v_dot2c_f32_bf16 v108, v214, v214
  v_dot2c_f32_bf16 v107, s55, v215
  v_dot2c_f32_bf16 v109, v215, v215
  v_dot2c_f32_bf16 v106, s55, v200
  v_dot2c_f32_bf16 v108, v200, v200
  v_dot2c_f32_bf16 v107, s55, v201
  v_dot2c_f32_bf16 v109, v201, v201
  v_dot2c_f32_bf16 v106, s55, v202
  v_dot2c_f32_bf16 v108, v202, v202
  v_dot2c_f32_bf16 v107, s55, v203
  v_dot2c_f32_bf16 v109, v203, v203
  v_dot2c_f32_bf16 v106, s55, v204
  v_dot2c_f32_bf16 v108, v204, v204
  v_dot2c_f32_bf16 v107, s55, v205
  v_dot2c_f32_bf16 v109, v205, v205
  v_dot2c_f32_bf16 v106, s55, v206
  v_dot2c_f32_bf16 v108, v206, v206
  v_dot2c_f32_bf16 v107, s55, v207
  v_dot2c_f32_bf16 v109, v207, v207
  v_dot2c_f32_bf16 v106, s55, v216
  v_dot2c_f32_bf16 v108, v216, v216
  v_dot2c_f32_bf16 v107, s55, v217
  v_dot2c_f32_bf16 v109, v217, v217
  v_dot2c_f32_bf16 v106, s55, v218
  v_dot2c_f32_bf16 v108, v218, v218
  v_dot2c_f32_bf16 v107, s55, v219
  v_dot2c_f32_bf16 v109, v219, v219
  v_dot2c_f32_bf16 v106, s55, v220
  v_dot2c_f32_bf16 v108, v220, v220
  v_dot2c_f32_bf16 v107, s55, v221
  v_dot2c_f32_bf16 v109, v221, v221
  v_dot2c_f32_bf16 v106, s55, v222
  v_dot2c_f32_bf16 v108, v222, v222
  v_dot2c_f32_bf16 v107, s55, v223
  v_dot2c_f32_bf16 v109, v223, v223
  s_mov_b32 vcc_lo, 0
  s_mov_b32 vcc_hi, -1
  v_mov_b32 v114, 0x05040100
  v_add_f32 v106, v106, v107
  v_add_f32 v108, v108, v109
  v_mov_b32 v115, 0x07060302
  v_lshrrev_b32 v116, 5, v1
  v_permlane32_swap_b32 v106, v108
  s_nop 0
  v_add_f32 v106, v106, v108
  v_mov_b32 v107, v106
  s_nop 1
  v_permlane16_swap_b32 v106, v107
  s_nop 0
  v_add_f32 v106, v106, v107
  s_nop 1
  v_add_f32_dpp v106, v106, v106 row_ror:8 row_mask:0xf bank_mask:0xf
  s_nop 1
  v_add_f32_dpp v106, v106, v106 row_ror:4 row_mask:0xf bank_mask:0xf
  s_nop 1
  v_add_f32_dpp v106, v106, v106 row_ror:2 row_mask:0xf bank_mask:0xf
  s_nop 1
  v_add_f32_dpp v106, v106, v106 row_ror:1 row_mask:0xf bank_mask:0xf
  s_lshl_b32 s75, s40, 4
  s_add_u32 s75, s75, 155904
  v_lshl_add_u32 v116, v116, 2, s75
  s_mov_b32 exec_lo, 1
  s_mov_b32 exec_hi, 1
  ds_write_b32 v116, v106
  s_mov_b64 exec, -1
  v_cndmask_b32 v114, v114, v115, vcc
  v_add_u32 v116, 155904, v4
  v_mov_b32 v108, s46
  v_mov_b32 v109, s46
  s_lshl_b32 s75, s45, 7
  s_add_u32 s75, s75, 0x20000
  s_waitcnt lgkmcnt(0)
  s_barrier
  s_cmp_eq_u32 s40, 0
  s_cbranch_scc0 L_m_nopub
  s_mov_b64 exec, 15
  ds_read_b64 v[106:107], v116
  s_waitcnt lgkmcnt(0)
  buffer_store_dwordx4 v[106:109], v4, s[32:35], s75 offen sc1
  s_mov_b64 exec, -1
L_m_nopub:
  v_cndmask_b32 v116, v192, v199, vcc
  v_cndmask_b32 v117, v200, v207, vcc
  v_cndmask_b32 v118, v208, v215, vcc
  v_cndmask_b32 v119, v216, v223, vcc
  v_perm_b32 v110, v117, v116, v114
  v_perm_b32 v111, v119, v118, v114
  v_mov_b32 v112, s46
  v_mov_b32 v113, s46
  s_add_u32 s75, s3, 24576
  buffer_store_dwordx4 v[110:113], v12, s[32:35], s75 offen sc1
  ds_write_b128 v3, v[216:219] offset:30720
  ds_write_b128 v3, v[220:223] offset:30736
  ds_write_b128 v3, v[200:203] offset:10240
  ds_write_b128 v3, v[204:207] offset:10256
  v_subrev_u32 v3, 40960, v3
  s_waitcnt lgkmcnt(0)
  s_barrier
  buffer_load_dwordx4 v[16:19], v4, s[32:35], s68 offen offset:0 sc1
  buffer_load_dwordx4 v[20:23], v4, s[32:35], s68 offen offset:1024 sc1
  buffer_load_dwordx4 v[24:27], v4, s[32:35], s68 offen offset:2048 sc1
  buffer_load_dwordx4 v[28:31], v4, s[32:35], s68 offen offset:3072 sc1
  s_add_u32 s68, s68, 4096
  buffer_load_dwordx4 v[32:35], v4, s[32:35], s68 offen offset:0 sc1
  buffer_load_dwordx4 v[36:39], v4, s[32:35], s68 offen offset:1024 sc1
  buffer_load_dwordx4 v[40:43], v4, s[32:35], s68 offen offset:2048 sc1
  buffer_load_dwordx4 v[44:47], v4, s[32:35], s68 offen offset:3072 sc1
  s_add_u32 s68, s68, 4096
  buffer_load_dwordx4 v[48:51], v4, s[32:35], s68 offen offset:0 sc1
  buffer_load_dwordx4 v[52:55], v4, s[32:35], s68 offen offset:1024 sc1
  buffer_load_dwordx4 v[56:59], v4, s[32:35], s68 offen offset:2048 sc1
  buffer_load_dwordx4 v[60:63], v4, s[32:35], s68 offen offset:3072 sc1
  s_add_u32 s68, s68, 4096
  ds_read_b128 v[160:163], v3 offset:0
  ds_read_b128 v[164:167], v3 offset:16
  ds_read_b128 v[168:171], v3 offset:10240
  ds_read_b128 v[172:175], v3 offset:10256
  ds_read_b128 v[176:179], v3 offset:20480
  ds_read_b128 v[180:183], v3 offset:20496
  ds_read_b128 v[184:187], v3 offset:30720
  ds_read_b128 v[188:191], v3 offset:30736
  v_add_u32 v14, 32, v14
  v_add_u32 v104, 1024, v104
  s_mov_b32 s25, 1
  s_add_u32 s4, s4, 65536
  s_mov_b32 s5, 0x7fff0000
  s_sub_u32 s6, s6, 4096
  s_sub_u32 s7, s7, 4096
  s_sub_u32 s8, s8, 4096
  s_waitcnt lgkmcnt(6)
  v_lshlrev_b32 v128, 16, v160
  v_and_b32 v129, s56, v160
  v_lshlrev_b32 v130, 16, v161
  v_and_b32 v131, s56, v161
  v_lshlrev_b32 v132, 16, v162
  v_and_b32 v133, s56, v162
  v_lshlrev_b32 v134, 16, v163
  v_and_b32 v135, s56, v163
  v_lshlrev_b32 v136, 16, v164
  v_and_b32 v137, s56, v164
  v_lshlrev_b32 v138, 16, v165
  v_and_b32 v139, s56, v165
  v_lshlrev_b32 v140, 16, v166
  v_and_b32 v141, s56, v166
  v_lshlrev_b32 v142, 16, v167
  v_and_b32 v143, s56, v167
  s_waitcnt lgkmcnt(4)
  v_lshlrev_b32 v224, 16, v168
  v_and_b32 v225, s56, v168
  v_lshlrev_b32 v226, 16, v169
  v_and_b32 v227, s56, v169
  v_lshlrev_b32 v228, 16, v170
  v_and_b32 v229, s56, v170
  v_lshlrev_b32 v230, 16, v171
  v_and_b32 v231, s56, v171
  v_lshlrev_b32 v232, 16, v172
  v_and_b32 v233, s56, v172
  v_lshlrev_b32 v234, 16, v173
  v_and_b32 v235, s56, v173
  v_lshlrev_b32 v236, 16, v174
  v_and_b32 v237, s56, v174
  v_lshlrev_b32 v238, 16, v175
  v_and_b32 v239, s56, v175
  s_waitcnt lgkmcnt(2)
  v_lshlrev_b32 v144, 16, v176
  v_and_b32 v145, s56, v176
  v_lshlrev_b32 v146, 16, v177
  v_and_b32 v147, s56, v177
  v_lshlrev_b32 v148, 16, v178
  v_and_b32 v149, s56, v178
  v_lshlrev_b32 v150, 16, v179
  v_and_b32 v151, s56, v179
  v_lshlrev_b32 v152, 16, v180
  v_and_b32 v153, s56, v180
  v_lshlrev_b32 v154, 16, v181
  v_and_b32 v155, s56, v181
  v_lshlrev_b32 v156, 16, v182
  v_and_b32 v157, s56, v182
  v_lshlrev_b32 v158, 16, v183
  v_and_b32 v159, s56, v183
  s_waitcnt lgkmcnt(0)
  v_lshlrev_b32 v240, 16, v184
  v_and_b32 v241, s56, v184
  v_lshlrev_b32 v242, 16, v185
  v_and_b32 v243, s56, v185
  v_lshlrev_b32 v244, 16, v186
  v_and_b32 v245, s56, v186
  v_lshlrev_b32 v246, 16, v187
  v_and_b32 v247, s56, v187
  v_lshlrev_b32 v248, 16, v188
  v_and_b32 v249, s56, v188
  v_lshlrev_b32 v250, 16, v189
  v_and_b32 v251, s56, v189
  v_lshlrev_b32 v252, 16, v190
  v_and_b32 v253, s56, v190
  v_lshlrev_b32 v254, 16, v191
  v_and_b32 v255, s56, v191
  s_branch L_mconv
L_mfinal:
  v_lshrrev_b32 v9, 2, v1
  v_and_b32 v12, 3, v1
  v_lshlrev_b32 v12, 4, v12
  s_lshl_b32 s75, s40, 5
  v_add_u32 v9, s75, v9
  v_lshl_add_u32 v13, v9, 15, v12
  v_add_u32 v14, 524288, v13
  v_mul_u32_u24 v9, 80, v9
  v_add_u32 v9, v9, v12
  v_add_u32 v9, 73984, v9
  s_nop 1
.p2align 3
  v_cvt_pk_bf16_f32 v200, v224, v225
  v_cvt_pk_bf16_f32 v201, v226, v227
  v_cvt_pk_bf16_f32 v202, v228, v229
  v_cvt_pk_bf16_f32 v203, v230, v231
  v_cvt_pk_bf16_f32 v204, v232, v233
  v_cvt_pk_bf16_f32 v205, v234, v235
  v_cvt_pk_bf16_f32 v206, v236, v237
  v_cvt_pk_bf16_f32 v207, v238, v239
  ds_write_b128 v3, v[200:203] offset:10240
  ds_write_b128 v3, v[204:207] offset:10256
  ds_read_b128 v[112:115], v9 offset:10240
  ds_read_b128 v[116:119], v9 offset:11520
.p2align 3
  v_cvt_pk_bf16_f32 v216, v240, v241
  v_cvt_pk_bf16_f32 v217, v242, v243
  v_cvt_pk_bf16_f32 v218, v244, v245
  v_cvt_pk_bf16_f32 v219, v246, v247
  v_cvt_pk_bf16_f32 v220, v248, v249
  v_cvt_pk_bf16_f32 v221, v250, v251
  v_cvt_pk_bf16_f32 v222, v252, v253
  v_cvt_pk_bf16_f32 v223, v254, v255
  ds_write_b128 v3, v[216:219] offset:30720
  ds_write_b128 v3, v[220:223] offset:30736
  ds_read_b128 v[120:123], v9 offset:30720
  ds_read_b128 v[124:127], v9 offset:32000
  s_waitcnt lgkmcnt(5)
  buffer_store_dwordx4 v[112:115], v13, s[36:39], s50 offen sc1
  s_waitcnt lgkmcnt(4)
  buffer_store_dwordx4 v[116:119], v14, s[36:39], s50 offen sc1
  s_waitcnt lgkmcnt(1)
  buffer_store_dwordx4 v[120:123], v13, s[36:39], s52 offen sc1
  s_waitcnt lgkmcnt(0)
  buffer_store_dwordx4 v[124:127], v14, s[36:39], s52 offen sc1
  s_branch L_fin
L_helper:
  s_sub_u32 s77, s40, 4
  v_lshl_add_u32 v12, v11, 15, v15
  v_add_u32 v87, 524288, v12
  v_lshlrev_b32 v88, 4, v11
  v_lshrrev_b32 v89, 1, v14
  v_lshl_add_u32 v88, v89, 11, v88
  v_mul_u32_u24 v11, 80, v11
  v_add_u32 v13, v11, v15
  v_add_u32 v13, 73984, v13
  s_add_u32 s73, s3, 28672
  s_lshl_b32 s78, s45, 7
  s_add_u32 s78, s78, 0x10000
  v_lshrrev_b32 v9, 5, v1
  s_lshl_b32 s75, s77, 3
  v_lshl_add_u32 v9, v9, 2, s75
  v_and_b32 v11, 31, v1
  v_mul_u32_u24 v14, 272, v11
  v_lshl_add_u32 v14, v9, 1, v14
  v_add_u32 v3, 272, v14
  v_lshlrev_b32 v7, 2, v9
  v_add_u32 v5, 158464, v7
  v_add_u32 v7, 156416, v7
  v_bfe_u32 v14, v1, 2, 2
  v_add_u32 v14, v9, v14
  v_mul_u32_u24 v14, 80, v14
  v_bfe_u32 v15, v1, 4, 1
  v_lshl_add_u32 v14, v15, 5, v14
  v_and_b32 v15, 3, v1
  v_lshl_add_u32 v14, v15, 3, v14
  v_add_u32 v2, 73984, v14
  v_add_u32 v14, 155904, v4
  v_mov_b64 v[92:93], 0
  v_mov_b64 v[94:95], 0
  s_waitcnt lgkmcnt(0)
  s_mul_i32 s46, s46, 0x9e3779b1
  s_add_u32 s46, s46, 0x7f4a7c15
  s_lshl_b32 s4, s41, 14
  s_add_u32 s4, s4, 0x10000
  v_and_b32 v89, 2, v0
  v_cmp_eq_u32 vcc, 2, v89
  v_mov_b32 v89, 0x05040100
  v_mov_b32 v90, 0x07060302
  v_cndmask_b32 v89, v89, v90, vcc
  v_mov_b32 v70, s46
  v_mov_b32 v71, s46
  v_mov_b32 v74, s46
  v_mov_b32 v75, s46
  v_lshrrev_b32 v91, 5, v1
  s_lshl_b32 s75, s77, 4
  s_add_u32 s75, s75, 155904
  v_lshl_add_u32 v91, v91, 2, s75
  v_lshrrev_b32 v0, 5, v1
  v_and_b32 v9, 3, v1
  v_lshl_add_u32 v0, v9, 1, v0
  v_lshlrev_b32 v0, 2, v0
  v_add_u32 v0, 155968, v0
  v_mov_b32 v6, 155968
  s_lshl_b32 s71, s77, 10
  s_add_u32 s3, s3, s71
  s_cmp_eq_u32 s42, 0
  s_cselect_b32 s74, 0, 131072
  s_sub_u32 s6, s3, s74
  s_add_u32 s6, s6, 12288
  s_add_u32 s7, s6, 4096
  s_add_u32 s8, s6, 8192
  s_cmp_eq_u32 s42, 31
  s_cselect_b32 s74, 0, 131072
  s_add_u32 s9, s3, s74
  s_add_u32 s10, s9, 4096
  s_add_u32 s11, s9, 8192
  s_lshr_b32 s68, s47, 3
  s_lshl_b32 s74, s41, 2
  s_add_u32 s68, s68, s74
  s_mul_i32 s68, s68, 196608
  s_and_b32 s74, s47, 7
  s_mul_i32 s74, s74, 12288
  s_add_u32 s68, s68, s74
  s_mul_i32 s74, s77, 3072
  s_add_u32 s68, s68, s74
  s_add_u32 s68, s68, 0x100000
  s_and_b32 s75, s44, 1
  s_mul_i32 s75, s75, 20480
  v_add_u32 v85, s75, v13
  s_sub_u32 s75, 20480, s75
  v_add_u32 v86, s75, v13
  s_barrier
  s_waitcnt vmcnt(7)
  ds_write_b128 v85, v[16:19] offset:0
  v_dot2c_f32_bf16 v92, s55, v16
  v_dot2c_f32_bf16 v94, v16, v16
  v_dot2c_f32_bf16 v93, s55, v17
  v_dot2c_f32_bf16 v95, v17, v17
  v_dot2c_f32_bf16 v92, s55, v18
  v_dot2c_f32_bf16 v94, v18, v18
  v_dot2c_f32_bf16 v93, s55, v19
  v_dot2c_f32_bf16 v95, v19, v19
  v_cndmask_b32 v64, v16, v19, vcc
  s_waitcnt vmcnt(6)
  ds_write_b128 v85, v[24:27] offset:10240
  v_dot2c_f32_bf16 v92, s55, v24
  v_dot2c_f32_bf16 v94, v24, v24
  v_dot2c_f32_bf16 v93, s55, v25
  v_dot2c_f32_bf16 v95, v25, v25
  v_dot2c_f32_bf16 v92, s55, v26
  v_dot2c_f32_bf16 v94, v26, v26
  v_dot2c_f32_bf16 v93, s55, v27
  v_dot2c_f32_bf16 v95, v27, v27
  v_cndmask_b32 v65, v24, v27, vcc
  v_perm_b32 v68, v65, v64, v89
  s_waitcnt vmcnt(5)
  ds_write_b128 v85, v[20:23] offset:1280
  v_dot2c_f32_bf16 v92, s55, v20
  v_dot2c_f32_bf16 v94, v20, v20
  v_dot2c_f32_bf16 v93, s55, v21
  v_dot2c_f32_bf16 v95, v21, v21
  v_dot2c_f32_bf16 v92, s55, v22
  v_dot2c_f32_bf16 v94, v22, v22
  v_dot2c_f32_bf16 v93, s55, v23
  v_dot2c_f32_bf16 v95, v23, v23
  v_cndmask_b32 v64, v20, v23, vcc
  s_waitcnt vmcnt(4)
  ds_write_b128 v85, v[28:31] offset:11520
  v_dot2c_f32_bf16 v92, s55, v28
  v_dot2c_f32_bf16 v94, v28, v28
  v_dot2c_f32_bf16 v93, s55, v29
  v_dot2c_f32_bf16 v95, v29, v29
  v_dot2c_f32_bf16 v92, s55, v30
  v_dot2c_f32_bf16 v94, v30, v30
  v_dot2c_f32_bf16 v93, s55, v31
  v_dot2c_f32_bf16 v95, v31, v31
  v_cndmask_b32 v65, v28, v31, vcc
  v_perm_b32 v72, v65, v64, v89
  s_waitcnt vmcnt(3)
  ds_write_b128 v86, v[32:35] offset:0
  v_dot2c_f32_bf16 v92, s55, v32
  v_dot2c_f32_bf16 v94, v32, v32
  v_dot2c_f32_bf16 v93, s55, v33
  v_dot2c_f32_bf16 v95, v33, v33
  v_dot2c_f32_bf16 v92, s55, v34
  v_dot2c_f32_bf16 v94, v34, v34
  v_dot2c_f32_bf16 v93, s55, v35
  v_dot2c_f32_bf16 v95, v35, v35
  v_cndmask_b32 v64, v32, v35, vcc
  s_waitcnt vmcnt(2)
  ds_write_b128 v86, v[40:43] offset:10240
  v_dot2c_f32_bf16 v92, s55, v40
  v_dot2c_f32_bf16 v94, v40, v40
  v_dot2c_f32_bf16 v93, s55, v41
  v_dot2c_f32_bf16 v95, v41, v41
  v_dot2c_f32_bf16 v92, s55, v42
  v_dot2c_f32_bf16 v94, v42, v42
  v_dot2c_f32_bf16 v93, s55, v43
  v_dot2c_f32_bf16 v95, v43, v43
  v_cndmask_b32 v65, v40, v43, vcc
  v_perm_b32 v69, v65, v64, v89
  s_waitcnt vmcnt(1)
  ds_write_b128 v86, v[36:39] offset:1280
  v_dot2c_f32_bf16 v92, s55, v36
  v_dot2c_f32_bf16 v94, v36, v36
  v_dot2c_f32_bf16 v93, s55, v37
  v_dot2c_f32_bf16 v95, v37, v37
  v_dot2c_f32_bf16 v92, s55, v38
  v_dot2c_f32_bf16 v94, v38, v38
  v_dot2c_f32_bf16 v93, s55, v39
  v_dot2c_f32_bf16 v95, v39, v39
  v_cndmask_b32 v64, v36, v39, vcc
  s_waitcnt vmcnt(0)
  ds_write_b128 v86, v[44:47] offset:11520
  v_dot2c_f32_bf16 v92, s55, v44
  v_dot2c_f32_bf16 v94, v44, v44
  v_dot2c_f32_bf16 v93, s55, v45
  v_dot2c_f32_bf16 v95, v45, v45
  v_dot2c_f32_bf16 v92, s55, v46
  v_dot2c_f32_bf16 v94, v46, v46
  v_dot2c_f32_bf16 v93, s55, v47
  v_dot2c_f32_bf16 v95, v47, v47
  v_cndmask_b32 v65, v44, v47, vcc
  v_perm_b32 v73, v65, v64, v89
  s_nop 0
  v_add_f32 v92, v92, v93
  v_add_f32 v94, v94, v95
  s_nop 1
  v_permlane32_swap_b32 v92, v94
  s_nop 0
  v_add_f32 v92, v92, v94
  v_mov_b32 v93, v92
  s_nop 1
  v_permlane16_swap_b32 v92, v93
  s_nop 0
  v_add_f32 v92, v92, v93
  s_nop 1
  v_add_f32_dpp v92, v92, v92 row_ror:8 row_mask:0xf bank_mask:0xf
  s_nop 1
  v_add_f32_dpp v92, v92, v92 row_ror:4 row_mask:0xf bank_mask:0xf
  s_nop 1
  v_add_f32_dpp v92, v92, v92 row_ror:2 row_mask:0xf bank_mask:0xf
  s_nop 1
  v_add_f32_dpp v92, v92, v92 row_ror:1 row_mask:0xf bank_mask:0xf
  s_mov_b32 exec_lo, 1
  s_mov_b32 exec_hi, 1
  ds_write_b32 v91, v92
  s_mov_b64 exec, -1
  s_waitcnt lgkmcnt(0)
  s_barrier
  s_cmp_eq_u32 s40, 4
  s_cbranch_scc0 L_h_nopub
  s_mov_b64 exec, 15
  ds_read_b64 v[76:77], v14
  v_mov_b32 v78, s46
  v_mov_b32 v79, s46
  s_waitcnt lgkmcnt(0)
  buffer_store_dwordx4 v[76:79], v4, s[32:35], s78 offen sc1
L_h_nopub:
  s_mov_b64 exec, -1
  s_bitcmp1_b32 s44, 0
  s_cbranch_scc0 L_h_noswap
  v_swap_b32 v68, v69
  v_swap_b32 v72, v73
L_h_noswap:
  s_mov_b32 exec_lo, 0x99999999
  s_mov_b32 exec_hi, 0x99999999
  buffer_store_dwordx4 v[68:71], v88, s[32:35], s73 offen offset:0 sc1
  buffer_store_dwordx4 v[72:75], v88, s[32:35], s73 offen offset:256 sc1
  s_mov_b64 exec, -1
  v_and_b32 v92, 7, v1
  v_lshlrev_b32 v92, 2, v92
  v_add_u32 v92, 156032, v92
  s_lshl_b32 s75, s77, 2
  s_add_u32 s75, s75, 156032
  v_mov_b32 v93, s75
  v_mov_b32 v94, 0
  v_mov_b32 v8, 1.0
  v_mov_b32 v9, 1.0
  s_mov_b32 s12, 1
  s_cmp_eq_u32 s25, 0
  s_cbranch_scc0 L_oc_19
  buffer_load_dwordx4 v[96:99], v12, s[28:31], s48 offen nt
  buffer_load_dwordx4 v[100:103], v87, s[28:31], s48 offen nt
  buffer_load_dwordx4 v[104:107], v12, s[28:31], s53 offen nt
  buffer_load_dwordx4 v[108:111], v87, s[28:31], s53 offen nt
  s_lshr_b32 s75, s77, 1
  s_mul_i32 s75, s75, 22624
  s_sub_u32 s75, s75, 73712
  v_add_u32 v13, s75, v13
  v_subrev_u32 v12, 73712, v2
  v_add_u32 v11, 36992, v12
L_oc_19:
  ds_read_b64_tr_b16 v[56:57], v2 offset:2560
  ds_read_b64_tr_b16 v[60:61], v2 offset:0
  ds_read_b64_tr_b16 v[64:65], v2 offset:5120
  ds_read_b64_tr_b16 v[68:69], v2 offset:7680
  ds_read_b64_tr_b16 v[48:49], v2 offset:20480
  ds_read_b64_tr_b16 v[50:51], v2 offset:23040
  ds_read_b64_tr_b16 v[52:53], v2 offset:25600
  ds_read_b64_tr_b16 v[54:55], v2 offset:28160
  s_waitcnt lgkmcnt(4)
  v_mov_b32 v62, v56
  v_mov_b32 v66, v57
  v_lshlrev_b32 v132, 16, v60
  v_and_b32 v133, s56, v60
  v_lshlrev_b32 v134, 16, v61
  v_and_b32 v135, s56, v61
  v_lshlrev_b32 v156, 16, v62
  v_and_b32 v157, s56, v62
  v_lshlrev_b32 v158, 16, v66
  v_and_b32 v159, s56, v66
  v_lshlrev_b32 v180, 16, v64
  v_and_b32 v181, s56, v64
  v_lshlrev_b32 v182, 16, v65
  v_and_b32 v183, s56, v65
  v_lshlrev_b32 v204, 16, v68
  v_and_b32 v205, s56, v68
  v_lshlrev_b32 v206, 16, v69
  v_and_b32 v207, s56, v69
  s_waitcnt lgkmcnt(0)
  v_lshlrev_b32 v140, 16, v48
  v_and_b32 v141, s56, v48
  v_lshlrev_b32 v142, 16, v49
  v_and_b32 v143, s56, v49
  v_lshlrev_b32 v164, 16, v50
  v_and_b32 v165, s56, v50
  v_lshlrev_b32 v166, 16, v51
  v_and_b32 v167, s56, v51
  v_lshlrev_b32 v188, 16, v52
  v_and_b32 v189, s56, v52
  v_lshlrev_b32 v190, 16, v53
  v_and_b32 v191, s56, v53
  v_lshlrev_b32 v212, 16, v54
  v_and_b32 v213, s56, v54
  v_lshlrev_b32 v214, 16, v55
  v_and_b32 v215, s56, v55
L_hconv:
  ds_read_b64_tr_b16 v[58:59], v2 offset:33280
  ds_read_b64_tr_b16 v[72:73], v2 offset:30720
  ds_read_b64_tr_b16 v[76:77], v2 offset:35840
  ds_read_b64_tr_b16 v[80:81], v2 offset:38400
  ds_read_b64_tr_b16 v[40:41], v2 offset:10240
  ds_read_b64_tr_b16 v[42:43], v2 offset:12800
  ds_read_b64_tr_b16 v[44:45], v2 offset:15360
  ds_read_b64_tr_b16 v[46:47], v2 offset:17920
  s_waitcnt lgkmcnt(4)
  v_mov_b32 v74, v58
  v_mov_b32 v78, v59
  v_lshlrev_b32 v144, 16, v72
  v_and_b32 v145, s56, v72
  v_lshlrev_b32 v146, 16, v73
  v_and_b32 v147, s56, v73
  v_lshlrev_b32 v168, 16, v74
  v_and_b32 v169, s56, v74
  v_lshlrev_b32 v170, 16, v78
  v_and_b32 v171, s56, v78
  v_lshlrev_b32 v192, 16, v76
  v_and_b32 v193, s56, v76
  v_lshlrev_b32 v194, 16, v77
  v_and_b32 v195, s56, v77
  v_lshlrev_b32 v216, 16, v80
  v_and_b32 v217, s56, v80
  v_lshlrev_b32 v218, 16, v81
  v_and_b32 v219, s56, v81
  s_waitcnt lgkmcnt(0)
  v_lshlrev_b32 v136, 16, v40
  v_and_b32 v137, s56, v40
  v_lshlrev_b32 v138, 16, v41
  v_and_b32 v139, s56, v41
  v_lshlrev_b32 v160, 16, v42
  v_and_b32 v161, s56, v42
  v_lshlrev_b32 v162, 16, v43
  v_and_b32 v163, s56, v43
  v_lshlrev_b32 v184, 16, v44
  v_and_b32 v185, s56, v44
  v_lshlrev_b32 v186, 16, v45
  v_and_b32 v187, s56, v45
  v_lshlrev_b32 v208, 16, v46
  v_and_b32 v209, s56, v46
  v_lshlrev_b32 v210, 16, v47
  v_and_b32 v211, s56, v47
  s_cmp_eq_u32 s25, 1
  s_cbranch_scc0 L_oc_20
  buffer_load_dwordx4 v[60:63], v4, s[32:35], s9 offen sc1
  buffer_load_dwordx4 v[64:67], v4, s[32:35], s10 offen sc1
  buffer_load_dwordx4 v[68:71], v4, s[32:35], s11 offen sc1
L_oc_20:
  s_cmp_eq_u32 s25, 0
  s_cbranch_scc0 L_oc_21
  s_waitcnt vmcnt(0)
  ds_write_b128 v13, v[96:99] offset:0
  ds_write_b128 v13, v[100:103] offset:1280
  ds_write_b128 v13, v[104:107] offset:36992
  ds_write_b128 v13, v[108:111] offset:38272
L_oc_21:
  s_mov_b32 s69, 0
  s_add_u32 s75, s4, 8192
  s_cmp_eq_u32 s25, 0
  s_cbranch_scc0 L_oc_24
  s_sleep 8
L_oc_24:
  s_cmp_eq_u32 s25, 1
  s_cbranch_scc0 L_oc_25
  s_sleep 3
L_oc_25:
L_pr_23:
  buffer_load_dwordx4 v[88:91], v10, s[32:35], s4 offen sc1
  buffer_load_dwordx4 v[112:115], v10, s[32:35], s75 offen sc1
L_pchk:
  s_waitcnt vmcnt(0)
L_pchk2:
  s_add_u32 s69, s69, 1
  v_cmp_eq_u32 vcc, s46, v90
  v_cmp_eq_u32 s[80:81], s46, v114
  s_and_b64 vcc, vcc, s[80:81]
  s_cmp_eq_u64 vcc, -1
  s_cbranch_scc1 L_pdone_22
  s_sleep 4
  s_cmp_lt_u32 s69, 40000
  s_cbranch_scc1 L_pr_23
L_pdone_22:
  v_pk_add_f32 v[88:89], v[88:89], v[112:113]
  s_nop 1
  v_permlane32_swap_b32 v88, v89
  s_nop 0
  v_add_f32 v88, v88, v89
  v_mov_b32 v90, v88
  s_nop 1
  v_permlane16_swap_b32 v88, v90
  s_nop 0
  v_add_f32 v88, v88, v90
  s_nop 1
  v_add_f32_dpp v88, v88, v88 row_ror:8 row_mask:0xf bank_mask:0xf
  s_nop 1
  v_add_f32_dpp v88, v88, v88 row_ror:4 row_mask:0xf bank_mask:0xf
  s_mov_b32 exec_lo, 15
  s_mov_b32 exec_hi, 15
  ds_add_f32 v0, v88
  s_mov_b64 exec, -1
  s_waitcnt lgkmcnt(0)
  s_barrier
  ds_read_b64 v[88:89], v6
  ds_read_b128 v[96:99], v7 offset:0
  ds_read_b128 v[112:115], v7 offset:512
  s_waitcnt lgkmcnt(2)
  v_mul_f32 v88, 0x36000000, v88
  v_mul_f32 v89, 0x36000000, v89
  v_fma_f32 v89, -v88, v88, v89
  v_max_f32 v89, 0, v89
  v_add_f32 v89, 0x3727c5ac, v89
  v_rsq_f32 v89, v89
  s_waitcnt lgkmcnt(0)
.p2align 3
  v_pk_mul_f32 v[96:97], v[96:97], v[88:89] op_sel:[0,1] op_sel_hi:[1,1]
  v_pk_mul_f32 v[98:99], v[98:99], v[88:89] op_sel:[0,1] op_sel_hi:[1,1]
  v_pk_fma_f32 v[112:113], v[96:97], v[88:89], v[112:113] op_sel:[0,0,0] op_sel_hi:[1,0,1] neg_lo:[1,0,0] neg_hi:[1,0,0]
  v_pk_fma_f32 v[114:115], v[98:99], v[88:89], v[114:115] op_sel:[0,0,0] op_sel_hi:[1,0,1] neg_lo:[1,0,0] neg_hi:[1,0,0]
  v_pk_fma_f32 v[136:137], v[136:137], v[96:97], v[112:113]
  v_pk_fma_f32 v[138:139], v[138:139], v[98:99], v[114:115]
  v_exp_f32 v16, v136
  v_exp_f32 v17, v137
  v_pk_fma_f32 v[140:141], v[140:141], v[96:97], v[112:113]
  v_exp_f32 v18, v138
  v_exp_f32 v19, v139
  v_pk_add_f32 v[16:17], v[16:17], v[8:9]
  v_pk_fma_f32 v[142:143], v[142:143], v[98:99], v[114:115]
  v_exp_f32 v20, v140
  v_exp_f32 v21, v141
  v_pk_add_f32 v[18:19], v[18:19], v[8:9]
  v_rcp_f32 v16, v16
  v_rcp_f32 v17, v17
  v_pk_fma_f32 v[132:133], v[132:133], v[96:97], v[112:113]
  v_exp_f32 v22, v142
  v_exp_f32 v23, v143
  v_pk_add_f32 v[20:21], v[20:21], v[8:9]
  v_rcp_f32 v18, v18
  v_rcp_f32 v19, v19
  v_pk_fma_f32 v[134:135], v[134:135], v[98:99], v[114:115]
  v_exp_f32 v224, v132
  v_exp_f32 v225, v133
  v_pk_add_f32 v[22:23], v[22:23], v[8:9]
  v_rcp_f32 v20, v20
  v_rcp_f32 v21, v21
  v_pk_fma_f32 v[144:145], v[144:145], v[96:97], v[112:113]
  v_exp_f32 v226, v134
  v_exp_f32 v227, v135
  v_pk_add_f32 v[224:225], v[224:225], v[8:9]
  v_rcp_f32 v22, v22
  v_rcp_f32 v23, v23
  v_pk_fma_f32 v[146:147], v[146:147], v[98:99], v[114:115]
  v_exp_f32 v228, v144
  v_exp_f32 v229, v145
  v_pk_add_f32 v[226:227], v[226:227], v[8:9]
  v_rcp_f32 v224, v224
  v_rcp_f32 v225, v225
  ds_read_b32 v95, v92 offset:32
  v_exp_f32 v230, v146
  v_exp_f32 v231, v147
  v_pk_add_f32 v[228:229], v[228:229], v[8:9]
  v_rcp_f32 v226, v226
  v_rcp_f32 v227, v227
  v_pk_add_f32 v[230:231], v[230:231], v[8:9]
  v_rcp_f32 v228, v228
  v_rcp_f32 v229, v229
  v_rcp_f32 v230, v230
  v_rcp_f32 v231, v231
  s_waitcnt lgkmcnt(0)
  v_cmp_le_u32 vcc, s12, v95
  s_cmp_eq_u64 vcc, -1
  s_cbranch_scc1 L_pok_26
L_psp_27:
  ds_read_b32 v95, v92 offset:32
  s_waitcnt lgkmcnt(0)
  v_cmp_le_u32 vcc, s12, v95
  s_cmp_eq_u64 vcc, -1
  s_cbranch_scc0 L_psp_27
L_pok_26:
  ds_read_b128 v[100:103], v5 offset:128
  ds_read_b128 v[104:107], v5 offset:256
  ds_read_b128 v[108:111], v5 offset:384
  ds_read_b128 v[116:119], v5 offset:640
  ds_read_b128 v[120:123], v5 offset:768
  ds_read_b128 v[124:127], v5 offset:896
.p2align 3
  v_pk_mul_f32 v[136:137], v[136:137], v[16:17]
  v_pk_mul_f32 v[138:139], v[138:139], v[18:19]
  v_pk_mul_f32 v[140:141], v[140:141], v[20:21]
  v_pk_mul_f32 v[142:143], v[142:143], v[22:23]
  v_pk_fma_f32 v[32:33], v[132:133], v[224:225], v[136:137]
  v_pk_fma_f32 v[34:35], v[134:135], v[226:227], v[138:139]
  v_pk_fma_f32 v[36:37], v[144:145], v[228:229], v[140:141]
  v_pk_fma_f32 v[38:39], v[146:147], v[230:231], v[142:143]
  v_pk_fma_f32 v[40:41], v[132:133], v[224:225], v[136:137] neg_lo:[1,0,0] neg_hi:[1,0,0]
  v_pk_fma_f32 v[42:43], v[134:135], v[226:227], v[138:139] neg_lo:[1,0,0] neg_hi:[1,0,0]
  v_pk_fma_f32 v[44:45], v[144:145], v[228:229], v[140:141] neg_lo:[0,0,1] neg_hi:[0,0,1]
  v_pk_fma_f32 v[46:47], v[146:147], v[230:231], v[142:143] neg_lo:[0,0,1] neg_hi:[0,0,1]
  v_cvt_pk_bf16_f32 v32, v32, v33
  v_cvt_pk_bf16_f32 v33, v34, v35
  ds_write_b64 v3, v[32:33] offset:9248
  v_cvt_pk_bf16_f32 v36, v36, v37
  v_cvt_pk_bf16_f32 v37, v38, v39
  ds_write_b64 v3, v[36:37] offset:46240
  v_cvt_pk_bf16_f32 v40, v40, v41
  v_cvt_pk_bf16_f32 v41, v42, v43
  ds_write_b64 v3, v[40:41] offset:18496
  v_cvt_pk_bf16_f32 v44, v44, v45
  v_cvt_pk_bf16_f32 v45, v46, v47
  ds_write_b64 v3, v[44:45] offset:55488
  v_add_u32 v94, 1, v94
  s_mov_b64 exec, 1
  ds_write_b32 v93, v94
  s_mov_b64 exec, -1
  s_cmp_eq_u32 s25, 1
  s_cbranch_scc0 L_oc_28
  s_add_u32 s71, s3, 12288
  buffer_store_dwordx4 v[72:75], v4, s[32:35], s71 offen sc1
  s_add_u32 s71, s3, 16384
  buffer_store_dwordx4 v[76:79], v4, s[32:35], s71 offen sc1
  s_add_u32 s71, s3, 20480
  buffer_store_dwordx4 v[80:83], v4, s[32:35], s71 offen sc1
L_oc_28:
  s_cmp_eq_u32 s25, 0
  s_cbranch_scc0 L_oc_29
  s_add_u32 s75, s44, s77
  s_cmp_eq_u32 s75, 0
  s_cbranch_scc0 L_h_noepoch
  v_mov_b32 v14, s46
  s_lshl_b32 s75, s41, 7
  s_mov_b64 exec, 1
  buffer_store_dword v14, v4, s[32:35], s75 offen sc1
  s_mov_b64 exec, -1
L_h_noepoch:
L_oc_29:
  s_waitcnt lgkmcnt(5)
.p2align 3
  v_fma_f32 v160, v160, v100, v116
  v_fma_f32 v161, v161, v101, v117
  v_fma_f32 v162, v162, v102, v118
  v_fma_f32 v163, v163, v103, v119
  v_exp_f32 v16, v160
  v_exp_f32 v17, v161
  v_fma_f32 v164, v164, v100, v116
  v_fma_f32 v165, v165, v101, v117
  v_exp_f32 v18, v162
  v_exp_f32 v19, v163
  v_add_f32 v16, 1.0, v16
  v_add_f32 v17, 1.0, v17
  v_fma_f32 v166, v166, v102, v118
  v_fma_f32 v167, v167, v103, v119
  v_exp_f32 v20, v164
  v_exp_f32 v21, v165
  v_add_f32 v18, 1.0, v18
  v_add_f32 v19, 1.0, v19
  v_rcp_f32 v16, v16
  v_rcp_f32 v17, v17
.p2align 3
  v_fma_f32 v156, v156, v100, v116
  v_fma_f32 v157, v157, v101, v117
  v_exp_f32 v22, v166
  v_exp_f32 v23, v167
  v_add_f32 v20, 1.0, v20
  v_add_f32 v21, 1.0, v21
  v_rcp_f32 v18, v18
  v_rcp_f32 v19, v19
  v_fma_f32 v158, v158, v102, v118
  v_fma_f32 v159, v159, v103, v119
  v_exp_f32 v232, v156
  v_exp_f32 v233, v157
  v_add_f32 v22, 1.0, v22
  v_add_f32 v23, 1.0, v23
  v_rcp_f32 v20, v20
  v_rcp_f32 v21, v21
  v_fma_f32 v168, v168, v100, v116
  v_fma_f32 v169, v169, v101, v117
  v_exp_f32 v234, v158
  v_exp_f32 v235, v159
  v_add_f32 v232, 1.0, v232
  v_add_f32 v233, 1.0, v233
  v_rcp_f32 v22, v22
  v_rcp_f32 v23, v23
  v_fma_f32 v170, v170, v102, v118
  v_fma_f32 v171, v171, v103, v119
  v_exp_f32 v236, v168
  v_exp_f32 v237, v169
  v_add_f32 v234, 1.0, v234
  v_add_f32 v235, 1.0, v235
  v_rcp_f32 v232, v232
  v_rcp_f32 v233, v233
  v_exp_f32 v238, v170
  v_exp_f32 v239, v171
  v_add_f32 v236, 1.0, v236
  v_add_f32 v237, 1.0, v237
  v_rcp_f32 v234, v234
  v_rcp_f32 v235, v235
  v_add_f32 v238, 1.0, v238
  v_add_f32 v239, 1.0, v239
  v_rcp_f32 v236, v236
  v_rcp_f32 v237, v237
  v_rcp_f32 v238, v238
  v_rcp_f32 v239, v239
  v_mul_f32 v160, v160, v16
  v_mul_f32 v161, v161, v17
  v_mul_f32 v162, v162, v18
  v_mul_f32 v163, v163, v19
  v_mul_f32 v164, v164, v20
  v_mul_f32 v165, v165, v21
  v_mul_f32 v166, v166, v22
  v_mul_f32 v167, v167, v23
.p2align 3
  v_fma_f32 v32, v156, v232, v160
  v_fma_f32 v33, v157, v233, v161
  v_fma_f32 v34, v158, v234, v162
  v_fma_f32 v35, v159, v235, v163
  v_fma_f32 v36, v168, v236, v164
  v_fma_f32 v37, v169, v237, v165
  v_cvt_pk_bf16_f32 v32, v32, v33
  v_fma_f32 v38, v170, v238, v166
  v_fma_f32 v39, v171, v239, v167
  v_cvt_pk_bf16_f32 v33, v34, v35
  ds_write_b64 v3, v[32:33] offset:9312
  v_fma_f32 v40, -v156, v232, v160
  v_fma_f32 v41, -v157, v233, v161
  v_cvt_pk_bf16_f32 v36, v36, v37
  v_fma_f32 v42, -v158, v234, v162
  v_fma_f32 v43, -v159, v235, v163
  v_cvt_pk_bf16_f32 v37, v38, v39
  ds_write_b64 v3, v[36:37] offset:46304
  v_fma_f32 v44, v168, v236, -v164
  v_fma_f32 v45, v169, v237, -v165
  v_cvt_pk_bf16_f32 v40, v40, v41
  v_fma_f32 v46, v170, v238, -v166
  v_fma_f32 v47, v171, v239, -v167
  v_cvt_pk_bf16_f32 v41, v42, v43
  ds_write_b64 v3, v[40:41] offset:18560
  v_cvt_pk_bf16_f32 v44, v44, v45
  v_cvt_pk_bf16_f32 v45, v46, v47
  ds_write_b64 v3, v[44:45] offset:55552
  v_add_u32 v94, 1, v94
  s_mov_b64 exec, 1
  ds_write_b32 v93, v94
  s_mov_b64 exec, -1
.p2align 3
  v_fma_f32 v184, v184, v104, v120
  v_fma_f32 v185, v185, v105, v121
  v_fma_f32 v186, v186, v106, v122
  v_fma_f32 v187, v187, v107, v123
  v_exp_f32 v16, v184
  v_exp_f32 v17, v185
  v_fma_f32 v188, v188, v104, v120
  v_fma_f32 v189, v189, v105, v121
  v_exp_f32 v18, v186
  v_exp_f32 v19, v187
  v_add_f32 v16, 1.0, v16
  v_add_f32 v17, 1.0, v17
  v_fma_f32 v190, v190, v106, v122
  v_fma_f32 v191, v191, v107, v123
  v_exp_f32 v20, v188
  v_exp_f32 v21, v189
  v_add_f32 v18, 1.0, v18
  v_add_f32 v19, 1.0, v19
  v_rcp_f32 v16, v16
  v_rcp_f32 v17, v17
  s_cmp_eq_u32 s25, 0
  s_cbranch_scc0 L_oc_30
  ds_read_b64_tr_b16 v[84:85], v12 offset:2560
  ds_read_b64_tr_b16 v[72:73], v12 offset:0
  ds_read_b64_tr_b16 v[76:77], v12 offset:27744
  ds_read_b64_tr_b16 v[80:81], v12 offset:30304
  ds_read_b64_tr_b16 v[86:87], v11 offset:2560
  ds_read_b64_tr_b16 v[60:61], v11 offset:0
  ds_read_b64_tr_b16 v[64:65], v11 offset:27744
  ds_read_b64_tr_b16 v[68:69], v11 offset:30304
L_oc_30:
.p2align 3
  v_fma_f32 v180, v180, v104, v120
  v_fma_f32 v181, v181, v105, v121
  v_exp_f32 v22, v190
  v_exp_f32 v23, v191
  v_add_f32 v20, 1.0, v20
  v_add_f32 v21, 1.0, v21
  v_rcp_f32 v18, v18
  v_rcp_f32 v19, v19
  v_fma_f32 v182, v182, v106, v122
  v_fma_f32 v183, v183, v107, v123
  v_exp_f32 v240, v180
  v_exp_f32 v241, v181
  v_add_f32 v22, 1.0, v22
  v_add_f32 v23, 1.0, v23
  v_rcp_f32 v20, v20
  v_rcp_f32 v21, v21
  v_fma_f32 v192, v192, v104, v120
  v_fma_f32 v193, v193, v105, v121
  v_exp_f32 v242, v182
  v_exp_f32 v243, v183
  v_add_f32 v240, 1.0, v240
  v_add_f32 v241, 1.0, v241
  v_rcp_f32 v22, v22
  v_rcp_f32 v23, v23
  v_fma_f32 v194, v194, v106, v122
  v_fma_f32 v195, v195, v107, v123
  v_exp_f32 v244, v192
  v_exp_f32 v245, v193
  v_add_f32 v242, 1.0, v242
  v_add_f32 v243, 1.0, v243
  v_rcp_f32 v240, v240
  v_rcp_f32 v241, v241
  v_exp_f32 v246, v194
  v_exp_f32 v247, v195
  v_add_f32 v244, 1.0, v244
  v_add_f32 v245, 1.0, v245
  v_rcp_f32 v242, v242
  v_rcp_f32 v243, v243
  v_add_f32 v246, 1.0, v246
  v_add_f32 v247, 1.0, v247
  v_rcp_f32 v244, v244
  v_rcp_f32 v245, v245
  v_rcp_f32 v246, v246
  v_rcp_f32 v247, v247
  v_mul_f32 v184, v184, v16
  v_mul_f32 v185, v185, v17
  v_mul_f32 v186, v186, v18
  v_mul_f32 v187, v187, v19
  v_mul_f32 v188, v188, v20
  v_mul_f32 v189, v189, v21
  v_mul_f32 v190, v190, v22
  v_mul_f32 v191, v191, v23
.p2align 3
  v_fma_f32 v32, v180, v240, v184
  v_fma_f32 v33, v181, v241, v185
  v_fma_f32 v34, v182, v242, v186
  v_fma_f32 v35, v183, v243, v187
  v_fma_f32 v36, v192, v244, v188
  v_fma_f32 v37, v193, v245, v189
  v_cvt_pk_bf16_f32 v32, v32, v33
  v_fma_f32 v38, v194, v246, v190
  v_fma_f32 v39, v195, v247, v191
  v_cvt_pk_bf16_f32 v33, v34, v35
  ds_write_b64 v3, v[32:33] offset:9376
  v_fma_f32 v40, -v180, v240, v184
  v_fma_f32 v41, -v181, v241, v185
  v_cvt_pk_bf16_f32 v36, v36, v37
  v_fma_f32 v42, -v182, v242, v186
  v_fma_f32 v43, -v183, v243, v187
  v_cvt_pk_bf16_f32 v37, v38, v39
  ds_write_b64 v3, v[36:37] offset:46368
  v_fma_f32 v44, v192, v244, -v188
  v_fma_f32 v45, v193, v245, -v189
  v_cvt_pk_bf16_f32 v40, v40, v41
  v_fma_f32 v46, v194, v246, -v190
  v_fma_f32 v47, v195, v247, -v191
  v_cvt_pk_bf16_f32 v41, v42, v43
  ds_write_b64 v3, v[40:41] offset:18624
  v_cvt_pk_bf16_f32 v44, v44, v45
  v_cvt_pk_bf16_f32 v45, v46, v47
  ds_write_b64 v3, v[44:45] offset:55616
  v_add_u32 v94, 1, v94
  s_mov_b64 exec, 1
  ds_write_b32 v93, v94
  s_mov_b64 exec, -1
  s_cmp_eq_u32 s25, 1
  s_cbranch_scc0 L_oc_31
  buffer_load_dwordx4 v[72:75], v4, s[32:35], s6 offen sc1
  buffer_load_dwordx4 v[76:79], v4, s[32:35], s7 offen sc1
  buffer_load_dwordx4 v[80:83], v4, s[32:35], s8 offen sc1
L_oc_31:
.p2align 3
  v_fma_f32 v208, v208, v108, v124
  v_fma_f32 v209, v209, v109, v125
  v_fma_f32 v210, v210, v110, v126
  v_fma_f32 v211, v211, v111, v127
  v_exp_f32 v16, v208
  v_exp_f32 v17, v209
  v_fma_f32 v212, v212, v108, v124
  v_fma_f32 v213, v213, v109, v125
  v_exp_f32 v18, v210
  v_exp_f32 v19, v211
  v_add_f32 v16, 1.0, v16
  v_add_f32 v17, 1.0, v17
  v_fma_f32 v214, v214, v110, v126
  v_fma_f32 v215, v215, v111, v127
  v_exp_f32 v20, v212
  v_exp_f32 v21, v213
  v_add_f32 v18, 1.0, v18
  v_add_f32 v19, 1.0, v19
  v_rcp_f32 v16, v16
  v_rcp_f32 v17, v17
  v_fma_f32 v204, v204, v108, v124
  v_fma_f32 v205, v205, v109, v125
  v_exp_f32 v22, v214
  v_exp_f32 v23, v215
  v_add_f32 v20, 1.0, v20
  v_add_f32 v21, 1.0, v21
  v_rcp_f32 v18, v18
  v_rcp_f32 v19, v19
  v_fma_f32 v206, v206, v110, v126
  v_fma_f32 v207, v207, v111, v127
  v_exp_f32 v248, v204
  v_exp_f32 v249, v205
  v_add_f32 v22, 1.0, v22
  v_add_f32 v23, 1.0, v23
  v_rcp_f32 v20, v20
  v_rcp_f32 v21, v21
  v_fma_f32 v216, v216, v108, v124
  v_fma_f32 v217, v217, v109, v125
  v_exp_f32 v250, v206
  v_exp_f32 v251, v207
  v_add_f32 v248, 1.0, v248
  v_add_f32 v249, 1.0, v249
  v_rcp_f32 v22, v22
  v_rcp_f32 v23, v23
  v_fma_f32 v218, v218, v110, v126
  v_fma_f32 v219, v219, v111, v127
  v_exp_f32 v252, v216
  v_exp_f32 v253, v217
  v_add_f32 v250, 1.0, v250
  v_add_f32 v251, 1.0, v251
  v_rcp_f32 v248, v248
  v_rcp_f32 v249, v249
  v_exp_f32 v254, v218
  v_exp_f32 v255, v219
  v_add_f32 v252, 1.0, v252
  v_add_f32 v253, 1.0, v253
  v_rcp_f32 v250, v250
  v_rcp_f32 v251, v251
  v_add_f32 v254, 1.0, v254
  v_add_f32 v255, 1.0, v255
  v_rcp_f32 v252, v252
  v_rcp_f32 v253, v253
  v_rcp_f32 v254, v254
  v_rcp_f32 v255, v255
  v_mul_f32 v208, v208, v16
  v_mul_f32 v209, v209, v17
  v_mul_f32 v210, v210, v18
  v_mul_f32 v211, v211, v19
  v_mul_f32 v212, v212, v20
  v_mul_f32 v213, v213, v21
  v_mul_f32 v214, v214, v22
  v_mul_f32 v215, v215, v23
.p2align 3
  v_fma_f32 v32, v204, v248, v208
  v_fma_f32 v33, v205, v249, v209
  v_fma_f32 v34, v206, v250, v210
  v_fma_f32 v35, v207, v251, v211
  v_fma_f32 v36, v216, v252, v212
  v_fma_f32 v37, v217, v253, v213
  v_cvt_pk_bf16_f32 v32, v32, v33
  v_fma_f32 v38, v218, v254, v214
  v_fma_f32 v39, v219, v255, v215
  v_cvt_pk_bf16_f32 v33, v34, v35
  ds_write_b64 v3, v[32:33] offset:9440
  v_fma_f32 v40, -v204, v248, v208
  v_fma_f32 v41, -v205, v249, v209
  v_cvt_pk_bf16_f32 v36, v36, v37
  v_fma_f32 v42, -v206, v250, v210
  v_fma_f32 v43, -v207, v251, v211
  v_cvt_pk_bf16_f32 v37, v38, v39
  ds_write_b64 v3, v[36:37] offset:46432
  v_fma_f32 v44, v216, v252, -v212
  v_fma_f32 v45, v217, v253, -v213
  v_cvt_pk_bf16_f32 v40, v40, v41
  v_fma_f32 v46, v218, v254, -v214
  v_fma_f32 v47, v219, v255, -v215
  v_cvt_pk_bf16_f32 v41, v42, v43
  ds_write_b64 v3, v[40:41] offset:18688
  v_cvt_pk_bf16_f32 v44, v44, v45
  v_cvt_pk_bf16_f32 v45, v46, v47
  ds_write_b64 v3, v[44:45] offset:55680
  v_add_u32 v94, 1, v94
  s_mov_b64 exec, 1
  ds_write_b32 v93, v94
  s_mov_b64 exec, -1
  s_cmp_eq_u32 s25, 0
  s_cbranch_scc0 L_hrows1
  s_waitcnt lgkmcnt(5)
  v_mov_b32 v74, v84
  v_mov_b32 v78, v85
  v_mov_b32 v62, v86
  v_mov_b32 v66, v87
  s_branch L_hok
L_hrows1:
  s_mov_b32 s69, 0
L_hchk:
  s_waitcnt vmcnt(0)
  v_cmp_eq_u32 vcc, s46, v63
  v_cmp_eq_u32 s[80:81], s46, v67
  s_and_b64 vcc, vcc, s[80:81]
  v_cmp_eq_u32 s[80:81], s46, v71
  s_and_b64 vcc, vcc, s[80:81]
  v_cmp_eq_u32 s[80:81], s46, v75
  s_and_b64 vcc, vcc, s[80:81]
  v_cmp_eq_u32 s[80:81], s46, v79
  s_and_b64 vcc, vcc, s[80:81]
  v_cmp_eq_u32 s[80:81], s46, v83
  s_and_b64 vcc, vcc, s[80:81]
  s_cmp_eq_u64 vcc, -1
  s_cbranch_scc1 L_hok
  s_add_u32 s69, s69, 1
  s_cmp_ge_u32 s69, 40000
  s_cbranch_scc1 L_hok
  buffer_load_dwordx4 v[72:75], v4, s[32:35], s6 offen sc1
  buffer_load_dwordx4 v[76:79], v4, s[32:35], s7 offen sc1
  buffer_load_dwordx4 v[80:83], v4, s[32:35], s8 offen sc1
  buffer_load_dwordx4 v[60:63], v4, s[32:35], s9 offen sc1
  buffer_load_dwordx4 v[64:67], v4, s[32:35], s10 offen sc1
  buffer_load_dwordx4 v[68:71], v4, s[32:35], s11 offen sc1
  s_branch L_hchk
L_hok:
  v_lshlrev_b32 v128, 16, v72
  v_and_b32 v129, s56, v72
  v_lshlrev_b32 v130, 16, v73
  v_and_b32 v131, s56, v73
  v_lshlrev_b32 v152, 16, v74
  v_and_b32 v153, s56, v74
  v_lshlrev_b32 v154, 16, v78
  v_and_b32 v155, s56, v78
.p2align 3
  v_fma_f32 v128, v128, v96, v112
  v_fma_f32 v129, v129, v97, v113
  v_fma_f32 v130, v130, v98, v114
  v_fma_f32 v131, v131, v99, v115
  v_exp_f32 v16, v128
  v_exp_f32 v17, v129
  v_fma_f32 v152, v152, v100, v116
  v_fma_f32 v153, v153, v101, v117
  v_exp_f32 v18, v130
  v_exp_f32 v19, v131
  v_add_f32 v16, s57, v16
  v_add_f32 v17, s57, v17
  v_fma_f32 v154, v154, v102, v118
  v_fma_f32 v155, v155, v103, v119
  v_exp_f32 v20, v152
  v_exp_f32 v21, v153
  v_add_f32 v18, s57, v18
  v_add_f32 v19, s57, v19
  v_rcp_f32 v16, v16
  v_rcp_f32 v17, v17
  v_exp_f32 v22, v154
  v_exp_f32 v23, v155
  v_add_f32 v20, s57, v20
  v_add_f32 v21, s57, v21
  v_rcp_f32 v18, v18
  v_rcp_f32 v19, v19
  v_add_f32 v22, s57, v22
  v_add_f32 v23, s57, v23
  v_rcp_f32 v20, v20
  v_rcp_f32 v21, v21
  v_rcp_f32 v22, v22
  v_rcp_f32 v23, v23
  s_cmp_eq_u32 s25, 0
  s_cbranch_scc0 L_oc_32
  s_mov_b32 s12, 3
L_psp_34:
  ds_read_b32 v95, v92 offset:0
  s_waitcnt lgkmcnt(0)
  v_cmp_le_u32 vcc, s12, v95
  s_cmp_eq_u64 vcc, -1
  s_cbranch_scc0 L_psp_34
L_pok_33:
L_oc_32:
.p2align 3
  v_fma_f32 v32, -v144, v228, v136
  v_fma_f32 v33, -v145, v229, v137
  v_fma_f32 v34, -v146, v230, v138
  v_fma_f32 v35, -v147, v231, v139
  v_fma_f32 v36, -v168, v236, v160
  v_fma_f32 v37, -v169, v237, v161
  v_cvt_pk_bf16_f32 v32, v32, v33
  v_fma_f32 v38, -v170, v238, v162
  v_fma_f32 v39, -v171, v239, v163
  v_cvt_pk_bf16_f32 v33, v34, v35
  ds_write_b64 v3, v[32:33] offset:36992
  v_fma_f32 v40, v128, v16, -v136
  v_fma_f32 v41, v129, v17, -v137
  v_cvt_pk_bf16_f32 v36, v36, v37
  v_fma_f32 v42, v130, v18, -v138
  v_fma_f32 v43, v131, v19, -v139
  v_cvt_pk_bf16_f32 v37, v38, v39
  ds_write_b64 v3, v[36:37] offset:37056
  v_fma_f32 v44, v152, v20, -v160
  v_fma_f32 v45, v153, v21, -v161
  v_cvt_pk_bf16_f32 v40, v40, v41
  v_fma_f32 v46, v154, v22, -v162
  v_fma_f32 v47, v155, v23, -v163
  v_cvt_pk_bf16_f32 v41, v42, v43
  ds_write_b64 v3, v[40:41] offset:0
  v_cvt_pk_bf16_f32 v44, v44, v45
  v_cvt_pk_bf16_f32 v45, v46, v47
  ds_write_b64 v3, v[44:45] offset:64
  v_add_u32 v94, 1, v94
  s_mov_b64 exec, 1
  ds_write_b32 v93, v94
  s_mov_b64 exec, -1
  v_lshlrev_b32 v176, 16, v76
  v_and_b32 v177, s56, v76
  v_lshlrev_b32 v178, 16, v77
  v_and_b32 v179, s56, v77
  v_lshlrev_b32 v200, 16, v80
  v_and_b32 v201, s56, v80
  v_lshlrev_b32 v202, 16, v81
  v_and_b32 v203, s56, v81
.p2align 3
  v_fma_f32 v176, v176, v104, v120
  v_fma_f32 v177, v177, v105, v121
  v_fma_f32 v178, v178, v106, v122
  v_fma_f32 v179, v179, v107, v123
  v_exp_f32 v16, v176
  v_exp_f32 v17, v177
  v_fma_f32 v200, v200, v108, v124
  v_fma_f32 v201, v201, v109, v125
  v_exp_f32 v18, v178
  v_exp_f32 v19, v179
  v_add_f32 v16, s57, v16
  v_add_f32 v17, s57, v17
  v_fma_f32 v202, v202, v110, v126
  v_fma_f32 v203, v203, v111, v127
  v_exp_f32 v20, v200
  v_exp_f32 v21, v201
  v_add_f32 v18, s57, v18
  v_add_f32 v19, s57, v19
  v_rcp_f32 v16, v16
  v_rcp_f32 v17, v17
  v_exp_f32 v22, v202
  v_exp_f32 v23, v203
  v_add_f32 v20, s57, v20
  v_add_f32 v21, s57, v21
  v_rcp_f32 v18, v18
  v_rcp_f32 v19, v19
  v_add_f32 v22, s57, v22
  v_add_f32 v23, s57, v23
  v_rcp_f32 v20, v20
  v_rcp_f32 v21, v21
  v_rcp_f32 v22, v22
  v_rcp_f32 v23, v23
.p2align 3
  v_fma_f32 v32, -v192, v244, v184
  v_fma_f32 v33, -v193, v245, v185
  v_fma_f32 v34, -v194, v246, v186
  v_fma_f32 v35, -v195, v247, v187
  v_fma_f32 v36, -v216, v252, v208
  v_fma_f32 v37, -v217, v253, v209
  v_cvt_pk_bf16_f32 v32, v32, v33
  v_fma_f32 v38, -v218, v254, v210
  v_fma_f32 v39, -v219, v255, v211
  v_cvt_pk_bf16_f32 v33, v34, v35
  ds_write_b64 v3, v[32:33] offset:37120
  v_fma_f32 v40, v176, v16, -v184
  v_fma_f32 v41, v177, v17, -v185
  v_cvt_pk_bf16_f32 v36, v36, v37
  v_fma_f32 v42, v178, v18, -v186
  v_fma_f32 v43, v179, v19, -v187
  v_cvt_pk_bf16_f32 v37, v38, v39
  ds_write_b64 v3, v[36:37] offset:37184
  v_fma_f32 v44, v200, v20, -v208
  v_fma_f32 v45, v201, v21, -v209
  v_cvt_pk_bf16_f32 v40, v40, v41
  v_fma_f32 v46, v202, v22, -v210
  v_fma_f32 v47, v203, v23, -v211
  v_cvt_pk_bf16_f32 v41, v42, v43
  ds_write_b64 v3, v[40:41] offset:128
  v_cvt_pk_bf16_f32 v44, v44, v45
  v_cvt_pk_bf16_f32 v45, v46, v47
  ds_write_b64 v3, v[44:45] offset:192
  v_add_u32 v94, 1, v94
  s_mov_b64 exec, 1
  ds_write_b32 v93, v94
  s_mov_b64 exec, -1
  v_lshlrev_b32 v148, 16, v60
  v_and_b32 v149, s56, v60
  v_lshlrev_b32 v150, 16, v61
  v_and_b32 v151, s56, v61
  v_lshlrev_b32 v172, 16, v62
  v_and_b32 v173, s56, v62
  v_lshlrev_b32 v174, 16, v66
  v_and_b32 v175, s56, v66
.p2align 3
  v_fma_f32 v148, v148, v96, v112
  v_fma_f32 v149, v149, v97, v113
  v_fma_f32 v150, v150, v98, v114
  v_fma_f32 v151, v151, v99, v115
  v_exp_f32 v16, v148
  v_exp_f32 v17, v149
  v_fma_f32 v172, v172, v100, v116
  v_fma_f32 v173, v173, v101, v117
  v_exp_f32 v18, v150
  v_exp_f32 v19, v151
  v_add_f32 v16, s58, v16
  v_add_f32 v17, s58, v17
  v_fma_f32 v174, v174, v102, v118
  v_fma_f32 v175, v175, v103, v119
  v_exp_f32 v20, v172
  v_exp_f32 v21, v173
  v_add_f32 v18, s58, v18
  v_add_f32 v19, s58, v19
  v_rcp_f32 v16, v16
  v_rcp_f32 v17, v17
  v_exp_f32 v22, v174
  v_exp_f32 v23, v175
  v_add_f32 v20, s58, v20
  v_add_f32 v21, s58, v21
  v_rcp_f32 v18, v18
  v_rcp_f32 v19, v19
  v_add_f32 v22, s58, v22
  v_add_f32 v23, s58, v23
  v_rcp_f32 v20, v20
  v_rcp_f32 v21, v21
  v_rcp_f32 v22, v22
  v_rcp_f32 v23, v23
.p2align 3
  v_fma_f32 v32, -v132, v224, v140
  v_fma_f32 v33, -v133, v225, v141
  v_fma_f32 v34, -v134, v226, v142
  v_fma_f32 v35, -v135, v227, v143
  v_fma_f32 v36, -v156, v232, v164
  v_fma_f32 v37, -v157, v233, v165
  v_cvt_pk_bf16_f32 v32, v32, v33
  v_fma_f32 v38, -v158, v234, v166
  v_fma_f32 v39, -v159, v235, v167
  v_cvt_pk_bf16_f32 v33, v34, v35
  ds_write_b64 v3, v[32:33] offset:27744
  v_fma_f32 v40, v148, v16, -v140
  v_fma_f32 v41, v149, v17, -v141
  v_cvt_pk_bf16_f32 v36, v36, v37
  v_fma_f32 v42, v150, v18, -v142
  v_fma_f32 v43, v151, v19, -v143
  v_cvt_pk_bf16_f32 v37, v38, v39
  ds_write_b64 v3, v[36:37] offset:27808
  v_fma_f32 v44, v172, v20, -v164
  v_fma_f32 v45, v173, v21, -v165
  v_cvt_pk_bf16_f32 v40, v40, v41
  v_fma_f32 v46, v174, v22, -v166
  v_fma_f32 v47, v175, v23, -v167
  v_cvt_pk_bf16_f32 v41, v42, v43
  ds_write_b64 v3, v[40:41] offset:64736
  v_cvt_pk_bf16_f32 v44, v44, v45
  v_cvt_pk_bf16_f32 v45, v46, v47
  ds_write_b64 v3, v[44:45] offset:64800
  v_add_u32 v94, 1, v94
  s_mov_b64 exec, 1
  ds_write_b32 v93, v94
  s_mov_b64 exec, -1
  v_lshlrev_b32 v196, 16, v64
  v_and_b32 v197, s56, v64
  v_lshlrev_b32 v198, 16, v65
  v_and_b32 v199, s56, v65
  v_lshlrev_b32 v220, 16, v68
  v_and_b32 v221, s56, v68
  v_lshlrev_b32 v222, 16, v69
  v_and_b32 v223, s56, v69
.p2align 3
  v_fma_f32 v196, v196, v104, v120
  v_fma_f32 v197, v197, v105, v121
  v_fma_f32 v198, v198, v106, v122
  v_fma_f32 v199, v199, v107, v123
  v_exp_f32 v16, v196
  v_exp_f32 v17, v197
  v_fma_f32 v220, v220, v108, v124
  v_fma_f32 v221, v221, v109, v125
  v_exp_f32 v18, v198
  v_exp_f32 v19, v199
  v_add_f32 v16, s58, v16
  v_add_f32 v17, s58, v17
  v_fma_f32 v222, v222, v110, v126
  v_fma_f32 v223, v223, v111, v127
  v_exp_f32 v20, v220
  v_exp_f32 v21, v221
  v_add_f32 v18, s58, v18
  v_add_f32 v19, s58, v19
  v_rcp_f32 v16, v16
  v_rcp_f32 v17, v17
  v_exp_f32 v22, v222
  v_exp_f32 v23, v223
  v_add_f32 v20, s58, v20
  v_add_f32 v21, s58, v21
  v_rcp_f32 v18, v18
  v_rcp_f32 v19, v19
  v_add_f32 v22, s58, v22
  v_add_f32 v23, s58, v23
  v_rcp_f32 v20, v20
  v_rcp_f32 v21, v21
  v_rcp_f32 v22, v22
  v_rcp_f32 v23, v23
.p2align 3
  v_fma_f32 v32, -v180, v240, v188
  v_fma_f32 v33, -v181, v241, v189
  v_fma_f32 v34, -v182, v242, v190
  v_fma_f32 v35, -v183, v243, v191
  v_fma_f32 v36, -v204, v248, v212
  v_fma_f32 v37, -v205, v249, v213
  v_cvt_pk_bf16_f32 v32, v32, v33
  v_fma_f32 v38, -v206, v250, v214
  v_fma_f32 v39, -v207, v251, v215
  v_cvt_pk_bf16_f32 v33, v34, v35
  ds_write_b64 v3, v[32:33] offset:27872
  v_fma_f32 v40, v196, v16, -v188
  v_fma_f32 v41, v197, v17, -v189
  v_cvt_pk_bf16_f32 v36, v36, v37
  v_fma_f32 v42, v198, v18, -v190
  v_fma_f32 v43, v199, v19, -v191
  v_cvt_pk_bf16_f32 v37, v38, v39
  ds_write_b64 v3, v[36:37] offset:27936
  v_fma_f32 v44, v220, v20, -v212
  v_fma_f32 v45, v221, v21, -v213
  v_cvt_pk_bf16_f32 v40, v40, v41
  v_fma_f32 v46, v222, v22, -v214
  v_fma_f32 v47, v223, v23, -v215
  v_cvt_pk_bf16_f32 v41, v42, v43
  ds_write_b64 v3, v[40:41] offset:64864
  v_cvt_pk_bf16_f32 v44, v44, v45
  v_cvt_pk_bf16_f32 v45, v46, v47
  ds_write_b64 v3, v[44:45] offset:64928
  v_add_u32 v94, 1, v94
  s_mov_b64 exec, 1
  ds_write_b32 v93, v94
  s_mov_b64 exec, -1
  s_lshl_b32 s12, s25, 3
  s_add_u32 s12, s12, 8
  s_cmp_eq_u32 s25, 1
  s_cbranch_scc1 L_hfinal
  v_add_u32 v2, 40960, v2
  v_add_u32 v7, 1024, v7
  v_add_u32 v0, 32, v0
  v_add_u32 v6, 32, v6
  s_mov_b32 s25, 1
  s_add_u32 s4, s4, 65536
  v_mov_b32 v63, s46
  v_mov_b32 v67, s46
  v_mov_b32 v70, s46
  v_mov_b32 v71, s46
  v_mov_b32 v75, s46
  v_mov_b32 v79, s46
  v_mov_b32 v82, s46
  v_mov_b32 v83, s46
  s_add_u32 s68, s68, 98304
L_psp_36:
  ds_read_b32 v95, v92 offset:64
  s_waitcnt lgkmcnt(0)
  v_cmp_le_u32 vcc, s12, v95
  s_cmp_eq_u64 vcc, -1
  s_cbranch_scc0 L_psp_36
L_pok_35:
  s_mov_b32 s12, 9
  ds_read_b64_tr_b16 v[56:57], v2 offset:2560
  ds_read_b64_tr_b16 v[60:61], v2 offset:0
  ds_read_b64_tr_b16 v[64:65], v2 offset:5120
  ds_read_b64_tr_b16 v[68:69], v2 offset:7680
  ds_read_b64_tr_b16 v[48:49], v2 offset:20480
  ds_read_b64_tr_b16 v[50:51], v2 offset:23040
  ds_read_b64_tr_b16 v[52:53], v2 offset:25600
  ds_read_b64_tr_b16 v[54:55], v2 offset:28160
  s_waitcnt lgkmcnt(4)
  v_mov_b32 v62, v56
  v_mov_b32 v66, v57
  v_min_u32 v14, 23, v1
  v_lshlrev_b32 v14, 7, v14
  buffer_load_dword v15, v14, s[32:35], s68 offen sc1
  s_add_u32 s71, s3, 0
  buffer_store_dwordx4 v[60:63], v4, s[32:35], s71 offen sc1
  s_add_u32 s71, s3, 4096
  buffer_store_dwordx4 v[64:67], v4, s[32:35], s71 offen sc1
  s_add_u32 s71, s3, 8192
  buffer_store_dwordx4 v[68:71], v4, s[32:35], s71 offen sc1
  v_lshlrev_b32 v132, 16, v60
  v_and_b32 v133, s56, v60
  v_lshlrev_b32 v134, 16, v61
  v_and_b32 v135, s56, v61
  v_lshlrev_b32 v156, 16, v62
  v_and_b32 v157, s56, v62
  v_lshlrev_b32 v158, 16, v66
  v_and_b32 v159, s56, v66
  v_lshlrev_b32 v180, 16, v64
  v_and_b32 v181, s56, v64
  v_lshlrev_b32 v182, 16, v65
  v_and_b32 v183, s56, v65
  v_lshlrev_b32 v204, 16, v68
  v_and_b32 v205, s56, v68
  v_lshlrev_b32 v206, 16, v69
  v_and_b32 v207, s56, v69
  s_waitcnt lgkmcnt(0)
  v_lshlrev_b32 v140, 16, v48
  v_and_b32 v141, s56, v48
  v_lshlrev_b32 v142, 16, v49
  v_and_b32 v143, s56, v49
  v_lshlrev_b32 v164, 16, v50
  v_and_b32 v165, s56, v50
  v_lshlrev_b32 v166, 16, v51
  v_and_b32 v167, s56, v51
  v_lshlrev_b32 v188, 16, v52
  v_and_b32 v189, s56, v52
  v_lshlrev_b32 v190, 16, v53
  v_and_b32 v191, s56, v53
  v_lshlrev_b32 v212, 16, v54
  v_and_b32 v213, s56, v54
  v_lshlrev_b32 v214, 16, v55
  v_and_b32 v215, s56, v55
  s_barrier
  s_barrier
  s_branch L_hconv
L_hfinal:
  v_lshrrev_b32 v9, 2, v1
  v_and_b32 v12, 3, v1
  v_lshlrev_b32 v12, 4, v12
  s_lshl_b32 s75, s77, 5
  v_add_u32 v9, s75, v9
  v_lshl_add_u32 v13, v9, 15, v12
  v_add_u32 v14, 524288, v13
  v_mul_u32_u24 v9, 80, v9
  v_add_u32 v9, v9, v12
  v_add_u32 v9, 73984, v9
L_psp_38:
  ds_read_b32 v95, v92 offset:64
  s_waitcnt lgkmcnt(0)
  v_cmp_le_u32 vcc, s12, v95
  s_cmp_eq_u64 vcc, -1
  s_cbranch_scc0 L_psp_38
L_pok_37:
  ds_read_b128 v[96:99], v9 offset:0
  ds_read_b128 v[100:103], v9 offset:1280
  ds_read_b128 v[104:107], v9 offset:20480
  ds_read_b128 v[108:111], v9 offset:21760
  s_waitcnt lgkmcnt(3)
  buffer_store_dwordx4 v[96:99], v13, s[36:39], s49 offen sc1
  s_waitcnt lgkmcnt(2)
  buffer_store_dwordx4 v[100:103], v14, s[36:39], s49 offen sc1
  s_waitcnt lgkmcnt(1)
  buffer_store_dwordx4 v[104:107], v13, s[36:39], s51 offen sc1
  s_waitcnt lgkmcnt(0)
  buffer_store_dwordx4 v[108:111], v14, s[36:39], s51 offen sc1
L_fin:
L_end:
  s_endpgm
.section .rodata,"a"
.p2align 6
.amdhsa_kernel standalone__adm_resblock__diffusion_kernel
  .amdhsa_next_free_vgpr 256
  .amdhsa_next_free_sgpr 102
  .amdhsa_accum_offset 256
  .amdhsa_group_segment_fixed_size 0
  .amdhsa_kernarg_size 96
  .amdhsa_user_sgpr_count 2
  .amdhsa_user_sgpr_kernarg_segment_ptr 1
  .amdhsa_system_sgpr_workgroup_id_x 1
.end_amdhsa_kernel
```
